```python
import torch

def _softmax(x, axis=-1):
    return torch.softmax(x, dim=axis)
def _gelu(x):
    return torch.nn.functional.gelu(x, approximate="tanh")
def _silu(x):
    return torch.nn.functional.silu(x)
def _sigmoid(x):
    return torch.sigmoid(x)
def _layernorm(x, axis=-1, eps=1e-5):
    m = x.mean(dim=axis, keepdim=True)
    v = x.var(dim=axis, keepdim=True, unbiased=False)
    return (x - m) / torch.sqrt(v + eps)
def _scatter_add(tgt, idx, src, axis=0):
    return tgt.clone().index_add_(axis, idx, src)
def _segment_sum(src, seg, n):
    out = torch.zeros((n,) + src.shape[1:], dtype=src.dtype)
    return out.index_add_(0, seg, src)
def _pad(x, pw):
    flat = tuple(v for pair in reversed(pw) for v in pair)
    return torch.nn.functional.pad(x, flat)

kernel_name = 'parallel_sum__gqa_block_cached__mixer_channel_mlp__decode'

def setup_inputs():

    _w = (lambda a: (lambda t: t.to(torch.bfloat16) if t.is_floating_point() else t)(torch.as_tensor(a)))
    def _A_setup():
        B, Sq, D = 8, 1, 448
        Hq, Hkv, Sk, Dh = 16, 8, 4096, 256
        assert Hq % Hkv == 0, (Hq, Hkv)
        return {
            "x": _w((lambda *s: torch.randn(*s, dtype=torch.bfloat16) * 0.05)(B, Sq, D)),
            "k_cache": _w((lambda *s: torch.randn(*s, dtype=torch.bfloat16) * 3.2)(B, Hkv, Sk, Dh)),
            "v_cache": _w((lambda *s: torch.randn(*s, dtype=torch.bfloat16) * 0.4)(B, Hkv, Sk, Dh)),
            "wq": _w((lambda *s: torch.randn(*s, dtype=torch.bfloat16) * 3.2)(D, Hq * Dh) * (D ** -0.5)),
            "wo": _w((lambda *s: torch.randn(*s, dtype=torch.bfloat16) * 0.4)(Hq * Dh, D) * ((Hq * Dh) ** -0.5)),
        }
    _A_in = _A_setup()

    def _B_setup():
        B, S, D, F = 8, 1, 448, 1792
        return {
            "x": _w((lambda *s: torch.randn(*s, dtype=torch.bfloat16) * 0.05)(B, S, D)),
            "w1": _w((lambda *s: torch.randn(*s, dtype=torch.bfloat16) * 3.2)(D, F) * (D ** -0.5)),
            "b1": _w((lambda *s: torch.randn(*s, dtype=torch.bfloat16) * 0.8)(F)),
            "w2": _w((lambda *s: torch.randn(*s, dtype=torch.bfloat16) * 0.1)(F, D) * (F ** -0.5)),
            "b2": _w((lambda *s: torch.randn(*s, dtype=torch.bfloat16) * 0.1)(D)),
        }
    _B_in = _B_setup()

    return {
        "A_x": _A_in["x"],
        "A_k_cache": _A_in["k_cache"],
        "A_v_cache": _A_in["v_cache"],
        "A_wq": _A_in["wq"],
        "A_wo": _A_in["wo"],
        "B_x": _B_in["x"],
        "B_w1": _B_in["w1"],
        "B_b1": _B_in["b1"],
        "B_w2": _B_in["w2"],
        "B_b2": _B_in["b2"],
    }

def reference(A_x, A_k_cache, A_v_cache, A_wq, A_wo, B_x, B_w1, B_b1, B_w2, B_b2):
    def _A_ref(x, k_cache, v_cache, wq, wo):
        B, Sq, D = x.shape
        Hq, Dh = 16, 256
        Hkv = k_cache.shape[1]
        rep = Hq // Hkv
        q = (lambda x, *d: x.permute(*d))((x @ wq).reshape(B, Sq, Hq, Dh), 0, 2, 1, 3)
        k = (lambda x, n, axis: torch.repeat_interleave(x, n, dim=axis))(k_cache, rep, axis=1)
        v = (lambda x, n, axis: torch.repeat_interleave(x, n, dim=axis))(v_cache, rep, axis=1)
        scores = torch.einsum("bhqd,bhkd->bhqk", q, k) * (Dh ** -0.5)
        p = _softmax(scores, axis=-1)
        o = torch.einsum("bhqk,bhkd->bhqd", p, v)
        return (lambda x, *d: x.permute(*d))(o, 0, 2, 1, 3).reshape(B, Sq, Hq * Dh) @ wo

    def _B_ref(x, w1, b1, w2, b2):
        y = _layernorm(x, axis=-1)
        h = _gelu(torch.einsum("bsd,df->bsf", y, w1) + b1)
        return torch.einsum("bsf,fd->bsd", h, w2) + b2

    x = A_x
    xn = _layernorm(x, axis=-1)
    return x + _A_ref(xn, A_k_cache, A_v_cache, A_wq, A_wo) + _B_ref(xn, B_w1, B_b1, B_w2, B_b2)
```

```asm
; @launch grid=(256,1,1) block=(640,1,1) lds=82304
.amdgcn_target "amdgcn-amd-amdhsa--gfx950"
.text
.globl parallel_sum__gqa_block_cached__mixer_channel_mlp__decode_kernel
.p2align 8
.type parallel_sum__gqa_block_cached__mixer_channel_mlp__decode_kernel,@function
parallel_sum__gqa_block_cached__mixer_channel_mlp__decode_kernel:
    s_cmp_ge_u32 s2, 256
    s_cbranch_scc1 L_end
    s_load_dwordx16 s[4:19], s[0:1], 0
    s_load_dwordx8 s[20:27], s[0:1], 64
    s_load_dwordx2 s[28:29], s[0:1], 96
    v_lshrrev_b32 v1, 6, v0
    v_and_b32 v0, 63, v0
    v_readfirstlane_b32 s30, v1
    s_and_b32 s31, s2, 7
    s_lshr_b32 s32, s2, 3
    s_lshr_b32 s33, s32, 2
    s_and_b32 s34, s32, 3
    s_lshl_b32 s37, s31, 2
    s_add_u32 s34, s34, s37
    s_lshl_b32 s38, s33, 5
    s_add_u32 s38, s38, s34
    s_cmp_ge_u32 s30, 8
    s_cbranch_scc1 L_helper
    v_and_b32 v1, 3, v0
    v_lshlrev_b32 v1, 4, v1
    v_lshrrev_b32 v3, 4, v0
    v_lshl_add_u32 v1, v3, 6, v1
    v_bfe_u32 v3, v0, 2, 1
    v_lshl_add_u32 v1, v3, 13, v1
    v_bfe_u32 v3, v0, 3, 1
    v_lshl_add_u32 v1, v3, 14, v1
    s_lshl_b32 s37, s38, 19
    s_mov_b32 s35, 0
    s_add_u32 s36, s30, s32
    s_and_b32 s36, s36, 7
    s_lshl_b32 s39, s32, 3
    s_or_b32 s36, s36, s39
    s_lshl_b32 s39, s31, 8
    s_or_b32 s36, s36, s39
    s_bfe_u32 s39, s36, 65546
    s_lshl_b32 s39, s39, 9
    s_or_b32 s35, s35, s39
    s_bfe_u32 s39, s36, 65539
    s_lshl_b32 s39, s39, 10
    s_or_b32 s35, s35, s39
    s_and_b32 s39, s36, 513
    s_bcnt1_i32_b32 s39, s39
    s_and_b32 s39, s39, 1
    s_lshl_b32 s39, s39, 12
    s_or_b32 s35, s35, s39
    s_bfe_u32 s39, s36, 65543
    s_lshl_b32 s39, s39, 18
    s_or_b32 s35, s35, s39
    s_bfe_u32 s39, s30, 65536
    s_lshl_b32 s39, s39, 16
    s_or_b32 s35, s35, s39
    s_bfe_u32 s39, s30, 65537
    s_lshl_b32 s39, s39, 15
    s_or_b32 s35, s35, s39
    s_bfe_u32 s39, s30, 65538
    s_lshl_b32 s39, s39, 11
    s_or_b32 s35, s35, s39
    s_waitcnt lgkmcnt(0)
    s_add_u32 s40, s6, s37
    s_addc_u32 s41, s7, 0
    s_mov_b32 s42, 524288
    s_mov_b32 s43, 0x20000
    s_xor_b32 s36, s35, 0
    buffer_load_dwordx4 v[56:59], v1, s[40:43], s36 offen offset:0 nt
    buffer_load_dwordx4 v[60:63], v1, s[40:43], s36 offen offset:256 nt
    s_xor_b32 s36, s35, 512
    buffer_load_dwordx4 v[64:67], v1, s[40:43], s36 offen offset:0 nt
    s_branch L_s2
L_helper:
    s_cmp_eq_u32 s30, 9
    s_cbranch_scc1 L_ctl
    s_getpc_b64 s[56:57]
    s_mov_b32 s58, 4352
    s_mov_b32 s59, 0x20000
    v_lshlrev_b32 v1, 6, v0
    buffer_load_dword v15, v1, s[56:59], 0 offen offset:256
    v_and_b32 v10, 15, v0
    v_lshrrev_b32 v9, 4, v0
    v_and_b32 v8, 7, v0
    v_mul_u32_u24 v8, 896, v8
    v_bfe_u32 v3, v0, 3, 1
    v_mul_u32_u24 v3, 448, v3
    v_lshl_add_u32 v8, v9, 4, v8
    v_add_u32 v8, v8, v3
    v_lshrrev_b32 v4, 3, v0
    v_lshlrev_b32 v1, 13, v4
    v_and_b32 v2, 7, v0
    v_lshl_add_u32 v1, v2, 4, v1
    v_mul_u32_u24 v4, 3584, v4
    v_lshl_add_u32 v4, v2, 4, v4
    s_and_b32 s63, s32, 1
    s_bfe_u32 s62, s32, 0x10001
    s_mul_i32 s64, s62, 224
    s_lshl_b32 s36, s63, 7
    s_add_u32 s64, s64, s36
    s_lshl_b32 s65, s63, 5
    s_sub_u32 s65, 127, s65
    s_lshr_b32 s66, s32, 2
    s_lshl_b32 s37, s64, 13
    s_lshl_b32 s39, s31, 3
    s_add_u32 s39, s39, s66
    s_lshl_b32 s39, s39, 7
    s_add_u32 s37, s37, s39
    s_lshl_b32 s39, s65, 13
    s_add_u32 s39, s39, 128
    s_lshl_b32 s60, s63, 8
    s_mul_i32 s61, s63, 192
    s_sub_u32 s61, 192, s61
    s_waitcnt lgkmcnt(0)
    s_load_dword s84, s[28:29], 0
    s_mov_b32 s48, s4
    s_mov_b32 s49, s5
    s_mov_b32 s50, 7168
    s_mov_b32 s51, 0x20000
    buffer_load_dwordx4 v[16:19], v8, s[48:51], s60 offen offset:0
    buffer_load_dwordx4 v[20:23], v8, s[48:51], s60 offen offset:64
    buffer_load_dwordx4 v[24:27], v8, s[48:51], s60 offen offset:128
    buffer_load_dwordx4 v[28:31], v8, s[48:51], s61 offen offset:0
    buffer_load_dwordx4 v[32:35], v8, s[48:51], s61 offen offset:64
    buffer_load_dwordx4 v[36:39], v8, s[48:51], s61 offen offset:128
    buffer_load_dwordx4 v[40:43], v8, s[48:51], s61 offen offset:192
    s_add_u32 s56, s10, s37
    s_addc_u32 s57, s11, 0
    s_mov_b32 s58, s39
    s_mov_b32 s59, 0x20000
    s_mov_b32 m0, 0
    s_mov_b32 s36, 0
    buffer_load_dwordx4 v1, s[56:59], s36 offen nt lds
    s_mov_b32 m0, 1024
    s_mov_b32 s36, 65536
    buffer_load_dwordx4 v1, s[56:59], s36 offen nt lds
    s_mov_b32 m0, 2048
    s_mov_b32 s36, 131072
    buffer_load_dwordx4 v1, s[56:59], s36 offen nt lds
    s_mov_b32 m0, 3072
    s_mov_b32 s36, 196608
    buffer_load_dwordx4 v1, s[56:59], s36 offen nt lds
    s_mov_b32 m0, 4096
    s_mov_b32 s36, 262144
    buffer_load_dwordx4 v1, s[56:59], s36 offen nt lds
    s_mov_b32 m0, 5120
    s_mov_b32 s36, 327680
    buffer_load_dwordx4 v1, s[56:59], s36 offen nt lds
    s_mov_b32 m0, 6144
    s_mov_b32 s36, 393216
    buffer_load_dwordx4 v1, s[56:59], s36 offen nt lds
    s_mov_b32 m0, 7168
    s_mov_b32 s36, 458752
    buffer_load_dwordx4 v1, s[56:59], s36 offen nt lds
    s_mov_b32 m0, 8192
    s_mov_b32 s36, 524288
    buffer_load_dwordx4 v1, s[56:59], s36 offen nt lds
    s_mov_b32 m0, 9216
    s_mov_b32 s36, 589824
    buffer_load_dwordx4 v1, s[56:59], s36 offen nt lds
    s_mov_b32 m0, 10240
    s_mov_b32 s36, 655360
    buffer_load_dwordx4 v1, s[56:59], s36 offen nt lds
    s_mov_b32 m0, 11264
    s_mov_b32 s36, 720896
    buffer_load_dwordx4 v1, s[56:59], s36 offen nt lds
    s_mov_b32 m0, 12288
    s_mov_b32 s36, 786432
    buffer_load_dwordx4 v1, s[56:59], s36 offen nt lds
    s_mov_b32 m0, 13312
    s_mov_b32 s36, 851968
    buffer_load_dwordx4 v1, s[56:59], s36 offen nt lds
    s_mov_b32 m0, 14336
    s_mov_b32 s36, 917504
    buffer_load_dwordx4 v1, s[56:59], s36 offen nt lds
    s_mov_b32 m0, 15360
    s_mov_b32 s36, 983040
    buffer_load_dwordx4 v1, s[56:59], s36 offen nt lds
    v_mov_b32 v126, -1
    v_mov_b32 v127, -1
    v_lshlrev_b32 v3, 3, v0
    v_add_u32 v3, 82048, v3
    v_mov_b32 v5, 82240
    s_mov_b64 exec, 0xffff
    ds_write_b64 v3, v[126:127]
    ds_write_b64 v5, v[126:127]
    s_mov_b64 exec, -1
    s_mov_b32 s52, s28
    s_mov_b32 s53, s29
    s_mov_b32 s54, 2621440
    s_mov_b32 s55, 0x20000
    v_lshlrev_b32 v2, 4, v0
    s_getreg_b32 s68, hwreg(HW_REG_XCC_ID)
    s_and_b32 s68, s68, 15
    s_lshl_b32 s68, s68, 12
    s_lshl_b32 s69, s31, 12
    s_add_u32 s69, s69, 32768
    s_lshl_b32 s37, s32, 7
    s_add_u32 s37, s37, s69
    s_waitcnt lgkmcnt(0)
    s_add_u32 s84, s84, 0x9E3779B9
    s_and_b32 s85, s84, 1023
    s_and_b32 s80, s84, 255
    s_or_b32 s68, s68, s85
    v_mov_b32 v6, s85
    v_mov_b32 v124, s68
    s_mov_b64 exec, 1
    buffer_store_dword v124, v2, s[52:55], s37 offen sc1
    s_mov_b64 exec, -1
    s_barrier
    v_and_b32 v125, 31, v0
    v_lshlrev_b32 v125, 7, v125
    v_mov_b32 v14, 0x7f000000
    s_mov_b32 s82, 1023
    s_mov_b32 s81, 255
    s_mov_b32 s83, 0x3db8aa3b
    v_bfe_u32 v3, v0, 2, 2
    v_lshl_add_u32 v12, v9, 3, v3
    v_lshlrev_b32 v12, 7, v12
    v_and_b32 v5, 3, v0
    v_lshl_add_u32 v12, v5, 3, v12
    v_and_b32 v5, 7, v0
    v_lshlrev_b32 v13, 17, v5
    v_lshl_add_u32 v13, v9, 4, v13
    v_bfe_u32 v3, v0, 3, 1
    v_cmp_eq_u32 vcc, s62, v3
    v_lshlrev_b32 v5, 12, v5
    v_lshl_add_u32 v5, v9, 4, v5
    v_cndmask_b32 v13, v14, v13, vcc
    v_cndmask_b32 v5, v14, v5, vcc
    s_and_b32 s37, s32, 3
    s_lshl_b32 s60, s37, 12
    s_lshl_b32 s39, s31, 14
    s_add_u32 s60, s60, s39
    s_lshl_b32 s39, s66, 9
    s_add_u32 s60, s60, s39
    s_add_u32 s60, s60, 851968
    s_lshl_b32 s70, s37, 10
    s_and_b32 s39, s66, 3
    s_lshl_b32 s39, s39, 8
    s_add_u32 s70, s70, s39
    s_lshl_b32 s39, s31, 15
    s_add_u32 s70, s70, s39
    s_add_u32 s70, s70, 589824
    s_waitcnt vmcnt(17)
    v_and_b32 v45, 0xffff0000, v16
    v_lshlrev_b32 v44, 16, v16
    v_and_b32 v47, 0xffff0000, v17
    v_lshlrev_b32 v46, 16, v17
    v_and_b32 v49, 0xffff0000, v18
    v_lshlrev_b32 v48, 16, v18
    v_and_b32 v51, 0xffff0000, v19
    v_lshlrev_b32 v50, 16, v19
    v_and_b32 v53, 0xffff0000, v20
    v_lshlrev_b32 v52, 16, v20
    v_and_b32 v55, 0xffff0000, v21
    v_lshlrev_b32 v54, 16, v21
    v_and_b32 v57, 0xffff0000, v22
    v_lshlrev_b32 v56, 16, v22
    v_and_b32 v59, 0xffff0000, v23
    v_lshlrev_b32 v58, 16, v23
    v_and_b32 v61, 0xffff0000, v24
    v_lshlrev_b32 v60, 16, v24
    v_and_b32 v63, 0xffff0000, v25
    v_lshlrev_b32 v62, 16, v25
    v_and_b32 v65, 0xffff0000, v26
    v_lshlrev_b32 v64, 16, v26
    v_and_b32 v67, 0xffff0000, v27
    v_lshlrev_b32 v66, 16, v27
    v_and_b32 v69, 0xffff0000, v28
    v_lshlrev_b32 v68, 16, v28
    v_and_b32 v71, 0xffff0000, v29
    v_lshlrev_b32 v70, 16, v29
    v_and_b32 v73, 0xffff0000, v30
    v_lshlrev_b32 v72, 16, v30
    v_and_b32 v75, 0xffff0000, v31
    v_lshlrev_b32 v74, 16, v31
    v_and_b32 v77, 0xffff0000, v32
    v_lshlrev_b32 v76, 16, v32
    v_and_b32 v79, 0xffff0000, v33
    v_lshlrev_b32 v78, 16, v33
    v_and_b32 v81, 0xffff0000, v34
    v_lshlrev_b32 v80, 16, v34
    v_and_b32 v83, 0xffff0000, v35
    v_lshlrev_b32 v82, 16, v35
    v_and_b32 v85, 0xffff0000, v36
    v_lshlrev_b32 v84, 16, v36
    v_and_b32 v87, 0xffff0000, v37
    v_lshlrev_b32 v86, 16, v37
    v_and_b32 v89, 0xffff0000, v38
    v_lshlrev_b32 v88, 16, v38
    v_and_b32 v91, 0xffff0000, v39
    v_lshlrev_b32 v90, 16, v39
    v_and_b32 v93, 0xffff0000, v40
    v_lshlrev_b32 v92, 16, v40
    v_and_b32 v95, 0xffff0000, v41
    v_lshlrev_b32 v94, 16, v41
    v_and_b32 v97, 0xffff0000, v42
    v_lshlrev_b32 v96, 16, v42
    v_and_b32 v99, 0xffff0000, v43
    v_lshlrev_b32 v98, 16, v43
    v_pk_add_f32 v[100:101], v[44:45], v[46:47]
    v_pk_add_f32 v[102:103], v[48:49], v[50:51]
    v_pk_add_f32 v[100:101], v[100:101], v[52:53]
    v_pk_add_f32 v[102:103], v[102:103], v[54:55]
    v_pk_add_f32 v[100:101], v[100:101], v[56:57]
    v_pk_add_f32 v[102:103], v[102:103], v[58:59]
    v_pk_add_f32 v[100:101], v[100:101], v[60:61]
    v_pk_add_f32 v[102:103], v[102:103], v[62:63]
    v_pk_add_f32 v[100:101], v[100:101], v[64:65]
    v_pk_add_f32 v[102:103], v[102:103], v[66:67]
    v_pk_add_f32 v[100:101], v[100:101], v[68:69]
    v_pk_add_f32 v[102:103], v[102:103], v[70:71]
    v_pk_add_f32 v[100:101], v[100:101], v[72:73]
    v_pk_add_f32 v[102:103], v[102:103], v[74:75]
    v_pk_add_f32 v[100:101], v[100:101], v[76:77]
    v_pk_add_f32 v[102:103], v[102:103], v[78:79]
    v_pk_add_f32 v[100:101], v[100:101], v[80:81]
    v_pk_add_f32 v[102:103], v[102:103], v[82:83]
    v_pk_add_f32 v[100:101], v[100:101], v[84:85]
    v_pk_add_f32 v[102:103], v[102:103], v[86:87]
    v_pk_add_f32 v[100:101], v[100:101], v[88:89]
    v_pk_add_f32 v[102:103], v[102:103], v[90:91]
    v_pk_add_f32 v[100:101], v[100:101], v[92:93]
    v_pk_add_f32 v[102:103], v[102:103], v[94:95]
    v_pk_add_f32 v[100:101], v[100:101], v[96:97]
    v_pk_add_f32 v[102:103], v[102:103], v[98:99]
    v_pk_add_f32 v[100:101], v[100:101], v[102:103]
    v_add_f32 v100, v100, v101
    s_nop 1
    v_add_f32_dpp v100, v100, v100 row_ror:8 row_mask:0xf bank_mask:0xf
    v_mov_b32 v101, v100
    s_nop 1
    v_permlane16_swap_b32 v100, v101
    v_add_f32 v100, v100, v101
    v_mov_b32 v101, v100
    s_nop 1
    v_permlane32_swap_b32 v100, v101
    v_add_f32 v100, v100, v101
    v_mul_f32 v100, 0xbb124925, v100
    v_mov_b32 v101, v100
    v_pk_add_f32 v[104:105], v[44:45], v[100:101]
    v_pk_mul_f32 v[102:103], v[104:105], v[104:105]
    v_pk_add_f32 v[106:107], v[46:47], v[100:101]
    v_pk_fma_f32 v[102:103], v[106:107], v[106:107], v[102:103]
    v_pk_add_f32 v[104:105], v[48:49], v[100:101]
    v_pk_fma_f32 v[102:103], v[104:105], v[104:105], v[102:103]
    v_pk_add_f32 v[106:107], v[50:51], v[100:101]
    v_pk_fma_f32 v[102:103], v[106:107], v[106:107], v[102:103]
    v_pk_add_f32 v[104:105], v[52:53], v[100:101]
    v_pk_fma_f32 v[102:103], v[104:105], v[104:105], v[102:103]
    v_pk_add_f32 v[106:107], v[54:55], v[100:101]
    v_pk_fma_f32 v[102:103], v[106:107], v[106:107], v[102:103]
    v_pk_add_f32 v[104:105], v[56:57], v[100:101]
    v_pk_fma_f32 v[102:103], v[104:105], v[104:105], v[102:103]
    v_pk_add_f32 v[106:107], v[58:59], v[100:101]
    v_pk_fma_f32 v[102:103], v[106:107], v[106:107], v[102:103]
    v_pk_add_f32 v[104:105], v[60:61], v[100:101]
    v_pk_fma_f32 v[102:103], v[104:105], v[104:105], v[102:103]
    v_pk_add_f32 v[106:107], v[62:63], v[100:101]
    v_pk_fma_f32 v[102:103], v[106:107], v[106:107], v[102:103]
    v_pk_add_f32 v[104:105], v[64:65], v[100:101]
    v_pk_fma_f32 v[102:103], v[104:105], v[104:105], v[102:103]
    v_pk_add_f32 v[106:107], v[66:67], v[100:101]
    v_pk_fma_f32 v[102:103], v[106:107], v[106:107], v[102:103]
    v_pk_add_f32 v[104:105], v[68:69], v[100:101]
    v_pk_fma_f32 v[102:103], v[104:105], v[104:105], v[102:103]
    v_pk_add_f32 v[106:107], v[70:71], v[100:101]
    v_pk_fma_f32 v[102:103], v[106:107], v[106:107], v[102:103]
    v_pk_add_f32 v[104:105], v[72:73], v[100:101]
    v_pk_fma_f32 v[102:103], v[104:105], v[104:105], v[102:103]
    v_pk_add_f32 v[106:107], v[74:75], v[100:101]
    v_pk_fma_f32 v[102:103], v[106:107], v[106:107], v[102:103]
    v_pk_add_f32 v[104:105], v[76:77], v[100:101]
    v_pk_fma_f32 v[102:103], v[104:105], v[104:105], v[102:103]
    v_pk_add_f32 v[106:107], v[78:79], v[100:101]
    v_pk_fma_f32 v[102:103], v[106:107], v[106:107], v[102:103]
    v_pk_add_f32 v[104:105], v[80:81], v[100:101]
    v_pk_fma_f32 v[102:103], v[104:105], v[104:105], v[102:103]
    v_pk_add_f32 v[106:107], v[82:83], v[100:101]
    v_pk_fma_f32 v[102:103], v[106:107], v[106:107], v[102:103]
    v_pk_add_f32 v[104:105], v[84:85], v[100:101]
    v_pk_fma_f32 v[102:103], v[104:105], v[104:105], v[102:103]
    v_pk_add_f32 v[106:107], v[86:87], v[100:101]
    v_pk_fma_f32 v[102:103], v[106:107], v[106:107], v[102:103]
    v_pk_add_f32 v[104:105], v[88:89], v[100:101]
    v_pk_fma_f32 v[102:103], v[104:105], v[104:105], v[102:103]
    v_pk_add_f32 v[106:107], v[90:91], v[100:101]
    v_pk_fma_f32 v[102:103], v[106:107], v[106:107], v[102:103]
    v_pk_add_f32 v[104:105], v[92:93], v[100:101]
    v_pk_fma_f32 v[102:103], v[104:105], v[104:105], v[102:103]
    v_pk_add_f32 v[106:107], v[94:95], v[100:101]
    v_pk_fma_f32 v[102:103], v[106:107], v[106:107], v[102:103]
    v_pk_add_f32 v[104:105], v[96:97], v[100:101]
    v_pk_fma_f32 v[102:103], v[104:105], v[104:105], v[102:103]
    v_pk_add_f32 v[106:107], v[98:99], v[100:101]
    v_pk_fma_f32 v[102:103], v[106:107], v[106:107], v[102:103]
    v_add_f32 v102, v102, v103
    s_nop 1
    v_add_f32_dpp v102, v102, v102 row_ror:8 row_mask:0xf bank_mask:0xf
    v_mov_b32 v103, v102
    s_nop 1
    v_permlane16_swap_b32 v102, v103
    v_add_f32 v102, v102, v103
    v_mov_b32 v103, v102
    s_nop 1
    v_permlane32_swap_b32 v102, v103
    v_add_f32 v102, v102, v103
    v_cvt_pk_bf16_f32 v100, v100, v100
    v_and_b32 v100, 0xffff0000, v100
    v_mov_b32 v101, v100
    v_mul_f32 v102, 0x3b124925, v102
    v_cvt_pk_bf16_f32 v102, v102, v102
    v_and_b32 v102, 0xffff0000, v102
    v_add_f32 v102, 0x3727c5ac, v102
    v_cvt_pk_bf16_f32 v102, v102, v102
    v_and_b32 v102, 0xffff0000, v102
    v_sqrt_f32 v102, v102
    v_pk_add_f32 v[44:45], v[44:45], v[100:101]
    v_pk_add_f32 v[46:47], v[46:47], v[100:101]
    v_pk_add_f32 v[48:49], v[48:49], v[100:101]
    v_pk_add_f32 v[50:51], v[50:51], v[100:101]
    v_pk_add_f32 v[52:53], v[52:53], v[100:101]
    v_pk_add_f32 v[54:55], v[54:55], v[100:101]
    v_pk_add_f32 v[56:57], v[56:57], v[100:101]
    v_pk_add_f32 v[58:59], v[58:59], v[100:101]
    v_pk_add_f32 v[60:61], v[60:61], v[100:101]
    v_pk_add_f32 v[62:63], v[62:63], v[100:101]
    v_pk_add_f32 v[64:65], v[64:65], v[100:101]
    v_pk_add_f32 v[66:67], v[66:67], v[100:101]
    v_pk_add_f32 v[68:69], v[68:69], v[100:101]
    v_pk_add_f32 v[70:71], v[70:71], v[100:101]
    v_pk_add_f32 v[72:73], v[72:73], v[100:101]
    v_pk_add_f32 v[74:75], v[74:75], v[100:101]
    v_pk_add_f32 v[76:77], v[76:77], v[100:101]
    v_pk_add_f32 v[78:79], v[78:79], v[100:101]
    v_pk_add_f32 v[80:81], v[80:81], v[100:101]
    v_pk_add_f32 v[82:83], v[82:83], v[100:101]
    v_pk_add_f32 v[84:85], v[84:85], v[100:101]
    v_pk_add_f32 v[86:87], v[86:87], v[100:101]
    v_pk_add_f32 v[88:89], v[88:89], v[100:101]
    v_pk_add_f32 v[90:91], v[90:91], v[100:101]
    v_pk_add_f32 v[92:93], v[92:93], v[100:101]
    v_pk_add_f32 v[94:95], v[94:95], v[100:101]
    v_pk_add_f32 v[96:97], v[96:97], v[100:101]
    v_pk_add_f32 v[98:99], v[98:99], v[100:101]
    v_cvt_pk_bf16_f32 v102, v102, v102
    v_and_b32 v102, 0xffff0000, v102
    v_rcp_f32 v102, v102
    v_cvt_pk_bf16_f32 v16, v44, v45
    v_cvt_pk_bf16_f32 v17, v46, v47
    v_cvt_pk_bf16_f32 v18, v48, v49
    v_cvt_pk_bf16_f32 v19, v50, v51
    v_cvt_pk_bf16_f32 v20, v52, v53
    v_cvt_pk_bf16_f32 v21, v54, v55
    v_cvt_pk_bf16_f32 v22, v56, v57
    v_cvt_pk_bf16_f32 v23, v58, v59
    v_cvt_pk_bf16_f32 v24, v60, v61
    v_cvt_pk_bf16_f32 v25, v62, v63
    v_cvt_pk_bf16_f32 v26, v64, v65
    v_cvt_pk_bf16_f32 v27, v66, v67
    v_cvt_pk_bf16_f32 v28, v68, v69
    v_cvt_pk_bf16_f32 v29, v70, v71
    v_cvt_pk_bf16_f32 v30, v72, v73
    v_cvt_pk_bf16_f32 v31, v74, v75
    v_cvt_pk_bf16_f32 v32, v76, v77
    v_cvt_pk_bf16_f32 v33, v78, v79
    v_cvt_pk_bf16_f32 v34, v80, v81
    v_cvt_pk_bf16_f32 v35, v82, v83
    v_cvt_pk_bf16_f32 v36, v84, v85
    v_cvt_pk_bf16_f32 v37, v86, v87
    v_cvt_pk_bf16_f32 v38, v88, v89
    v_cvt_pk_bf16_f32 v39, v90, v91
    v_cvt_pk_bf16_f32 v40, v92, v93
    v_cvt_pk_bf16_f32 v41, v94, v95
    v_cvt_pk_bf16_f32 v42, v96, v97
    v_cvt_pk_bf16_f32 v43, v98, v99
    v_mov_b32 v103, v102
    v_and_b32 v45, 0xffff0000, v16
    v_lshlrev_b32 v44, 16, v16
    v_and_b32 v47, 0xffff0000, v17
    v_lshlrev_b32 v46, 16, v17
    v_and_b32 v49, 0xffff0000, v18
    v_lshlrev_b32 v48, 16, v18
    v_and_b32 v51, 0xffff0000, v19
    v_lshlrev_b32 v50, 16, v19
    v_and_b32 v53, 0xffff0000, v20
    v_lshlrev_b32 v52, 16, v20
    v_and_b32 v55, 0xffff0000, v21
    v_lshlrev_b32 v54, 16, v21
    v_and_b32 v57, 0xffff0000, v22
    v_lshlrev_b32 v56, 16, v22
    v_and_b32 v59, 0xffff0000, v23
    v_lshlrev_b32 v58, 16, v23
    v_and_b32 v61, 0xffff0000, v24
    v_lshlrev_b32 v60, 16, v24
    v_and_b32 v63, 0xffff0000, v25
    v_lshlrev_b32 v62, 16, v25
    v_and_b32 v65, 0xffff0000, v26
    v_lshlrev_b32 v64, 16, v26
    v_and_b32 v67, 0xffff0000, v27
    v_lshlrev_b32 v66, 16, v27
    v_and_b32 v69, 0xffff0000, v28
    v_lshlrev_b32 v68, 16, v28
    v_and_b32 v71, 0xffff0000, v29
    v_lshlrev_b32 v70, 16, v29
    v_and_b32 v73, 0xffff0000, v30
    v_lshlrev_b32 v72, 16, v30
    v_and_b32 v75, 0xffff0000, v31
    v_lshlrev_b32 v74, 16, v31
    v_and_b32 v77, 0xffff0000, v32
    v_lshlrev_b32 v76, 16, v32
    v_and_b32 v79, 0xffff0000, v33
    v_lshlrev_b32 v78, 16, v33
    v_and_b32 v81, 0xffff0000, v34
    v_lshlrev_b32 v80, 16, v34
    v_and_b32 v83, 0xffff0000, v35
    v_lshlrev_b32 v82, 16, v35
    v_and_b32 v85, 0xffff0000, v36
    v_lshlrev_b32 v84, 16, v36
    v_and_b32 v87, 0xffff0000, v37
    v_lshlrev_b32 v86, 16, v37
    v_and_b32 v89, 0xffff0000, v38
    v_lshlrev_b32 v88, 16, v38
    v_and_b32 v91, 0xffff0000, v39
    v_lshlrev_b32 v90, 16, v39
    v_and_b32 v93, 0xffff0000, v40
    v_lshlrev_b32 v92, 16, v40
    v_and_b32 v95, 0xffff0000, v41
    v_lshlrev_b32 v94, 16, v41
    v_and_b32 v97, 0xffff0000, v42
    v_lshlrev_b32 v96, 16, v42
    v_and_b32 v99, 0xffff0000, v43
    v_lshlrev_b32 v98, 16, v43
    v_pk_mul_f32 v[44:45], v[44:45], v[102:103]
    v_pk_mul_f32 v[46:47], v[46:47], v[102:103]
    v_pk_mul_f32 v[48:49], v[48:49], v[102:103]
    v_pk_mul_f32 v[50:51], v[50:51], v[102:103]
    v_pk_mul_f32 v[52:53], v[52:53], v[102:103]
    v_pk_mul_f32 v[54:55], v[54:55], v[102:103]
    v_pk_mul_f32 v[56:57], v[56:57], v[102:103]
    v_pk_mul_f32 v[58:59], v[58:59], v[102:103]
    v_pk_mul_f32 v[60:61], v[60:61], v[102:103]
    v_pk_mul_f32 v[62:63], v[62:63], v[102:103]
    v_pk_mul_f32 v[64:65], v[64:65], v[102:103]
    v_pk_mul_f32 v[66:67], v[66:67], v[102:103]
    v_pk_mul_f32 v[68:69], v[68:69], v[102:103]
    v_pk_mul_f32 v[70:71], v[70:71], v[102:103]
    v_pk_mul_f32 v[72:73], v[72:73], v[102:103]
    v_pk_mul_f32 v[74:75], v[74:75], v[102:103]
    v_pk_mul_f32 v[76:77], v[76:77], v[102:103]
    v_pk_mul_f32 v[78:79], v[78:79], v[102:103]
    v_pk_mul_f32 v[80:81], v[80:81], v[102:103]
    v_pk_mul_f32 v[82:83], v[82:83], v[102:103]
    v_pk_mul_f32 v[84:85], v[84:85], v[102:103]
    v_pk_mul_f32 v[86:87], v[86:87], v[102:103]
    v_pk_mul_f32 v[88:89], v[88:89], v[102:103]
    v_pk_mul_f32 v[90:91], v[90:91], v[102:103]
    v_pk_mul_f32 v[92:93], v[92:93], v[102:103]
    v_pk_mul_f32 v[94:95], v[94:95], v[102:103]
    v_pk_mul_f32 v[96:97], v[96:97], v[102:103]
    v_pk_mul_f32 v[98:99], v[98:99], v[102:103]
    v_cvt_pk_bf16_f32 v16, v44, v45
    v_cvt_pk_bf16_f32 v17, v46, v47
    v_cvt_pk_bf16_f32 v18, v48, v49
    v_cvt_pk_bf16_f32 v19, v50, v51
    v_cvt_pk_bf16_f32 v20, v52, v53
    v_cvt_pk_bf16_f32 v21, v54, v55
    v_cvt_pk_bf16_f32 v22, v56, v57
    v_cvt_pk_bf16_f32 v23, v58, v59
    v_cvt_pk_bf16_f32 v24, v60, v61
    v_cvt_pk_bf16_f32 v25, v62, v63
    v_cvt_pk_bf16_f32 v26, v64, v65
    v_cvt_pk_bf16_f32 v27, v66, v67
    v_cvt_pk_bf16_f32 v28, v68, v69
    v_cvt_pk_bf16_f32 v29, v70, v71
    v_cvt_pk_bf16_f32 v30, v72, v73
    v_cvt_pk_bf16_f32 v31, v74, v75
    v_cvt_pk_bf16_f32 v32, v76, v77
    v_cvt_pk_bf16_f32 v33, v78, v79
    v_cvt_pk_bf16_f32 v34, v80, v81
    v_cvt_pk_bf16_f32 v35, v82, v83
    v_cvt_pk_bf16_f32 v36, v84, v85
    v_cvt_pk_bf16_f32 v37, v86, v87
    v_cvt_pk_bf16_f32 v38, v88, v89
    v_cvt_pk_bf16_f32 v39, v90, v91
    v_cvt_pk_bf16_f32 v40, v92, v93
    v_cvt_pk_bf16_f32 v41, v94, v95
    v_cvt_pk_bf16_f32 v42, v96, v97
    v_cvt_pk_bf16_f32 v43, v98, v99
    s_mov_b64 exec, 0xffffffff
    buffer_load_dword v124, v125, s[52:55], s69 offen sc1
    s_mov_b64 exec, -1
    s_waitcnt vmcnt(2) lgkmcnt(0)
    ds_read_b64_tr_b16 v[44:45], v12 offset:0
    ds_read_b64_tr_b16 v[46:47], v12 offset:512
    ds_read_b64_tr_b16 v[48:49], v12 offset:4096
    ds_read_b64_tr_b16 v[50:51], v12 offset:4608
    ds_read_b64_tr_b16 v[52:53], v12 offset:8192
    ds_read_b64_tr_b16 v[54:55], v12 offset:8704
    ds_read_b64_tr_b16 v[56:57], v12 offset:12288
    ds_read_b64_tr_b16 v[58:59], v12 offset:12800
    ds_read_b64_tr_b16 v[60:61], v12 offset:32
    ds_read_b64_tr_b16 v[62:63], v12 offset:544
    ds_read_b64_tr_b16 v[64:65], v12 offset:4128
    ds_read_b64_tr_b16 v[66:67], v12 offset:4640
    v_mov_b32 v130, s84
    v_mov_b32 v131, s84
    v_mov_b32 v134, s84
    v_mov_b32 v135, s84
    v_mov_b32 v138, s84
    v_mov_b32 v139, s84
    v_mov_b32 v142, s84
    v_mov_b32 v143, s84
    ds_read_b64_tr_b16 v[68:69], v12 offset:8224
    ds_read_b64_tr_b16 v[70:71], v12 offset:8736
    s_waitcnt lgkmcnt(12)
    v_mfma_f32_16x16x32_bf16 v[108:111], v[44:47], v[16:19], 0
    ds_read_b64_tr_b16 v[72:73], v12 offset:12320
    ds_read_b64_tr_b16 v[74:75], v12 offset:12832
    s_waitcnt lgkmcnt(12)
    v_mfma_f32_16x16x32_bf16 v[108:111], v[48:51], v[20:23], v[108:111]
    ds_read_b64_tr_b16 v[76:77], v12 offset:64
    ds_read_b64_tr_b16 v[78:79], v12 offset:576
    s_waitcnt lgkmcnt(12)
    v_mfma_f32_16x16x32_bf16 v[108:111], v[52:55], v[24:27], v[108:111]
    ds_read_b64_tr_b16 v[80:81], v12 offset:4160
    ds_read_b64_tr_b16 v[82:83], v12 offset:4672
    s_waitcnt lgkmcnt(12)
    v_mfma_f32_16x16x32_bf16 v[108:111], v[56:59], v[28:31], v[108:111]
    ds_read_b64_tr_b16 v[84:85], v12 offset:8256
    ds_read_b64_tr_b16 v[86:87], v12 offset:8768
    s_waitcnt lgkmcnt(12)
    v_mfma_f32_16x16x32_bf16 v[112:115], v[60:63], v[16:19], 0
    ds_read_b64_tr_b16 v[88:89], v12 offset:12352
    ds_read_b64_tr_b16 v[90:91], v12 offset:12864
    s_waitcnt lgkmcnt(12)
    v_mfma_f32_16x16x32_bf16 v[112:115], v[64:67], v[20:23], v[112:115]
    ds_read_b64_tr_b16 v[92:93], v12 offset:96
    ds_read_b64_tr_b16 v[94:95], v12 offset:608
    s_waitcnt lgkmcnt(12)
    v_mfma_f32_16x16x32_bf16 v[112:115], v[68:71], v[24:27], v[112:115]
    ds_read_b64_tr_b16 v[96:97], v12 offset:4192
    ds_read_b64_tr_b16 v[98:99], v12 offset:4704
    s_waitcnt lgkmcnt(12)
    v_mfma_f32_16x16x32_bf16 v[112:115], v[72:75], v[28:31], v[112:115]
    ds_read_b64_tr_b16 v[100:101], v12 offset:8288
    ds_read_b64_tr_b16 v[102:103], v12 offset:8800
    s_waitcnt lgkmcnt(12)
    v_mfma_f32_16x16x32_bf16 v[116:119], v[76:79], v[16:19], 0
    ds_read_b64_tr_b16 v[104:105], v12 offset:12384
    ds_read_b64_tr_b16 v[106:107], v12 offset:12896
    s_waitcnt lgkmcnt(12)
    v_mfma_f32_16x16x32_bf16 v[116:119], v[80:83], v[20:23], v[116:119]
    s_waitcnt lgkmcnt(10)
    v_mfma_f32_16x16x32_bf16 v[116:119], v[84:87], v[24:27], v[116:119]
    s_waitcnt lgkmcnt(8)
    v_mfma_f32_16x16x32_bf16 v[116:119], v[88:91], v[28:31], v[116:119]
    s_waitcnt lgkmcnt(6)
    v_mfma_f32_16x16x32_bf16 v[120:123], v[92:95], v[16:19], 0
    s_waitcnt lgkmcnt(4)
    v_mfma_f32_16x16x32_bf16 v[120:123], v[96:99], v[20:23], v[120:123]
    s_waitcnt lgkmcnt(2)
    v_mfma_f32_16x16x32_bf16 v[120:123], v[100:103], v[24:27], v[120:123]
    s_waitcnt lgkmcnt(0)
    v_mfma_f32_16x16x32_bf16 v[120:123], v[104:107], v[28:31], v[120:123]
    s_waitcnt vmcnt(0)
    v_cmp_ne_u32 vcc, s68, v124
    s_nop 0
    s_cmp_eq_u32 vcc_lo, 0
    s_cbranch_scc1 L_xok
    s_mov_b64 exec, 0xffffffff
    buffer_load_dword v124, v125, s[52:55], s69 offen sc1
    s_mov_b64 exec, -1
    s_waitcnt vmcnt(0)
    v_cmp_ne_u32 vcc, s68, v124
    s_nop 0
    s_cmp_eq_u32 vcc_lo, 0
L_xok:
    s_cselect_b32 s87, 1, 0
    v_mov_b32 v128, v108
    v_mov_b32 v129, v109
    s_cmp_eq_u32 s87, 0
    s_cbranch_scc1 L_wt1
    buffer_store_dwordx4 v[128:131], v13, s[52:55], s60 offen offset:0
    s_branch L_we1
L_wt1:
    buffer_store_dwordx4 v[128:131], v13, s[52:55], s60 offen offset:0 sc1
L_we1:
    v_mov_b32 v132, v110
    v_mov_b32 v133, v111
    s_cmp_eq_u32 s87, 0
    s_cbranch_scc1 L_wt2
    buffer_store_dwordx4 v[132:135], v13, s[52:55], s60 offen offset:64
    s_branch L_we2
L_wt2:
    buffer_store_dwordx4 v[132:135], v13, s[52:55], s60 offen offset:64 sc1
L_we2:
    v_mov_b32 v136, v112
    v_mov_b32 v137, v113
    s_cmp_eq_u32 s87, 0
    s_cbranch_scc1 L_wt3
    buffer_store_dwordx4 v[136:139], v13, s[52:55], s60 offen offset:128
    s_branch L_we3
L_wt3:
    buffer_store_dwordx4 v[136:139], v13, s[52:55], s60 offen offset:128 sc1
L_we3:
    v_mov_b32 v140, v114
    v_mov_b32 v141, v115
    s_cmp_eq_u32 s87, 0
    s_cbranch_scc1 L_wt4
    buffer_store_dwordx4 v[140:143], v13, s[52:55], s60 offen offset:192
    s_branch L_we4
L_wt4:
    buffer_store_dwordx4 v[140:143], v13, s[52:55], s60 offen offset:192 sc1
L_we4:
    v_mov_b32 v128, v116
    v_mov_b32 v129, v117
    s_cmp_eq_u32 s87, 0
    s_cbranch_scc1 L_wt5
    buffer_store_dwordx4 v[128:131], v13, s[52:55], s60 offen offset:256
    s_branch L_we5
L_wt5:
    buffer_store_dwordx4 v[128:131], v13, s[52:55], s60 offen offset:256 sc1
L_we5:
    v_mov_b32 v132, v118
    v_mov_b32 v133, v119
    s_cmp_eq_u32 s87, 0
    s_cbranch_scc1 L_wt6
    buffer_store_dwordx4 v[132:135], v13, s[52:55], s60 offen offset:320
    s_branch L_we6
L_wt6:
    buffer_store_dwordx4 v[132:135], v13, s[52:55], s60 offen offset:320 sc1
L_we6:
    v_mov_b32 v136, v120
    v_mov_b32 v137, v121
    s_cmp_eq_u32 s87, 0
    s_cbranch_scc1 L_wt7
    buffer_store_dwordx4 v[136:139], v13, s[52:55], s60 offen offset:384
    s_branch L_we7
L_wt7:
    buffer_store_dwordx4 v[136:139], v13, s[52:55], s60 offen offset:384 sc1
L_we7:
    v_mov_b32 v140, v122
    v_mov_b32 v141, v123
    s_cmp_eq_u32 s87, 0
    s_cbranch_scc1 L_wt8
    buffer_store_dwordx4 v[140:143], v13, s[52:55], s60 offen offset:448
    s_branch L_we8
L_wt8:
    buffer_store_dwordx4 v[140:143], v13, s[52:55], s60 offen offset:448 sc1
L_we8:
    s_lshr_b32 s61, s38, 2
    s_lshl_b32 s61, s61, 14
    s_add_u32 s61, s61, 851968
    s_mov_b32 s72, s84
    s_mov_b32 s73, s84
    s_mov_b32 s86, 65536
L_qpoll:
    s_sleep 16
    s_mov_b32 s36, s61
    buffer_load_dwordx4 v[44:47], v2, s[52:55], s36 offen offset:0 sc1
    buffer_load_dwordx4 v[48:51], v2, s[52:55], s36 offen offset:1024 sc1
    buffer_load_dwordx4 v[52:55], v2, s[52:55], s36 offen offset:2048 sc1
    buffer_load_dwordx4 v[56:59], v2, s[52:55], s36 offen offset:3072 sc1
    s_add_u32 s36, s36, 4096
    buffer_load_dwordx4 v[60:63], v2, s[52:55], s36 offen offset:0 sc1
    buffer_load_dwordx4 v[64:67], v2, s[52:55], s36 offen offset:1024 sc1
    buffer_load_dwordx4 v[68:71], v2, s[52:55], s36 offen offset:2048 sc1
    buffer_load_dwordx4 v[72:75], v2, s[52:55], s36 offen offset:3072 sc1
    s_add_u32 s36, s36, 4096
    buffer_load_dwordx4 v[76:79], v2, s[52:55], s36 offen offset:0 sc1
    buffer_load_dwordx4 v[80:83], v2, s[52:55], s36 offen offset:1024 sc1
    buffer_load_dwordx4 v[84:87], v2, s[52:55], s36 offen offset:2048 sc1
    buffer_load_dwordx4 v[88:91], v2, s[52:55], s36 offen offset:3072 sc1
    s_add_u32 s36, s36, 4096
    buffer_load_dwordx4 v[92:95], v2, s[52:55], s36 offen offset:0 sc1
    buffer_load_dwordx4 v[96:99], v2, s[52:55], s36 offen offset:1024 sc1
    buffer_load_dwordx4 v[100:103], v2, s[52:55], s36 offen offset:2048 sc1
    buffer_load_dwordx4 v[104:107], v2, s[52:55], s36 offen offset:3072 sc1
    s_mov_b64 exec, 0xffffffff
    buffer_load_dword v124, v125, s[52:55], s69 offen sc1
    s_mov_b64 exec, -1
    s_waitcnt vmcnt(0)
    s_mov_b64 vcc, 0
    v_cmp_ne_u64 s[74:75], s[72:73], v[46:47]
    v_cmp_ne_u64 s[76:77], s[72:73], v[50:51]
    v_cmp_ne_u64 s[78:79], s[72:73], v[54:55]
    s_or_b64 vcc, vcc, s[74:75]
    v_cmp_ne_u64 s[74:75], s[72:73], v[58:59]
    s_or_b64 vcc, vcc, s[76:77]
    v_cmp_ne_u64 s[76:77], s[72:73], v[62:63]
    s_or_b64 vcc, vcc, s[78:79]
    v_cmp_ne_u64 s[78:79], s[72:73], v[66:67]
    s_or_b64 vcc, vcc, s[74:75]
    v_cmp_ne_u64 s[74:75], s[72:73], v[70:71]
    s_or_b64 vcc, vcc, s[76:77]
    v_cmp_ne_u64 s[76:77], s[72:73], v[74:75]
    s_or_b64 vcc, vcc, s[78:79]
    v_cmp_ne_u64 s[78:79], s[72:73], v[78:79]
    s_or_b64 vcc, vcc, s[74:75]
    v_cmp_ne_u64 s[74:75], s[72:73], v[82:83]
    s_or_b64 vcc, vcc, s[76:77]
    v_cmp_ne_u64 s[76:77], s[72:73], v[86:87]
    s_or_b64 vcc, vcc, s[78:79]
    v_cmp_ne_u64 s[78:79], s[72:73], v[90:91]
    s_or_b64 vcc, vcc, s[74:75]
    v_cmp_ne_u64 s[74:75], s[72:73], v[94:95]
    s_or_b64 vcc, vcc, s[76:77]
    v_cmp_ne_u64 s[76:77], s[72:73], v[98:99]
    s_or_b64 vcc, vcc, s[78:79]
    v_cmp_ne_u64 s[78:79], s[72:73], v[102:103]
    s_or_b64 vcc, vcc, s[74:75]
    v_cmp_ne_u64 s[74:75], s[72:73], v[106:107]
    s_or_b64 vcc, vcc, s[76:77]
    s_or_b64 vcc, vcc, s[78:79]
    s_or_b64 vcc, vcc, s[74:75]
    s_sub_u32 s86, s86, 1
    s_cbranch_scc1 L_qdone
    s_cbranch_vccnz L_qpoll
L_qdone:
    v_cmp_ne_u32 vcc, s68, v124
    s_nop 0
    s_cmp_eq_u32 vcc_lo, 0
    s_cselect_b32 s87, 1, 0
    v_pk_add_f32 v[44:45], v[44:45], v[60:61]
    v_pk_add_f32 v[48:49], v[48:49], v[64:65]
    v_pk_add_f32 v[52:53], v[52:53], v[68:69]
    v_pk_add_f32 v[56:57], v[56:57], v[72:73]
    v_pk_add_f32 v[44:45], v[44:45], v[76:77]
    v_pk_add_f32 v[48:49], v[48:49], v[80:81]
    v_pk_add_f32 v[52:53], v[52:53], v[84:85]
    v_pk_add_f32 v[56:57], v[56:57], v[88:89]
    v_pk_add_f32 v[44:45], v[44:45], v[92:93]
    v_pk_add_f32 v[48:49], v[48:49], v[96:97]
    v_pk_add_f32 v[52:53], v[52:53], v[100:101]
    v_pk_add_f32 v[56:57], v[56:57], v[104:105]
    v_lshrrev_b32 v3, 3, v0
    v_lshlrev_b32 v3, 5, v3
    v_and_b32 v15, 3, v0
    v_lshl_add_u32 v3, v15, 3, v3
    v_and_b32 v15, 4, v0
    v_add_u32 v3, v3, v15
    v_add_u32 v3, 81024, v3
    v_mov_b32 v13, 82240
    v_mov_b32 v108, s84
    v_mov_b32 v109, s87
    v_cvt_pk_bf16_f32 v44, v44, v45
    ds_write_b32 v3, v44 offset:0
    v_cvt_pk_bf16_f32 v48, v48, v49
    ds_write_b32 v3, v48 offset:256
    v_cvt_pk_bf16_f32 v52, v52, v53
    ds_write_b32 v3, v52 offset:512
    v_cvt_pk_bf16_f32 v56, v56, v57
    ds_write_b32 v3, v56 offset:768
    s_waitcnt lgkmcnt(0)
    ds_write_b64 v13, v[108:109]
    s_cmp_ge_u32 s66, 4
    s_cbranch_scc0 L_noh
    s_mul_i32 s67, s31, 7
    s_lshr_b32 s67, s67, 1
    s_and_b32 s39, s66, 3
    s_add_u32 s67, s67, s39
    s_mul_i32 s37, s64, 3584
    s_lshl_b32 s39, s67, 7
    s_add_u32 s37, s37, s39
    s_mul_i32 s39, s65, 3584
    s_add_u32 s39, s39, 128
    s_add_u32 s56, s16, s37
    s_addc_u32 s57, s17, 0
    s_mov_b32 s58, s39
    s_mov_b32 s59, 0x20000
    s_mov_b32 s36, 0
    s_mov_b32 s62, 16384
    s_mov_b32 s63, 16
L_w1:
    s_mov_b32 m0, s62
    s_waitcnt vmcnt(7)
    buffer_load_dwordx4 v4, s[56:59], s36 offen nt lds
    s_add_u32 s36, s36, 28672
    s_add_u32 s62, s62, 1024
    s_sub_u32 s63, s63, 1
    s_cmp_lg_u32 s63, 0
    s_cbranch_scc1 L_w1
    v_and_b32 v45, 0xffff0000, v16
    v_lshlrev_b32 v44, 16, v16
    v_and_b32 v47, 0xffff0000, v17
    v_lshlrev_b32 v46, 16, v17
    v_and_b32 v49, 0xffff0000, v18
    v_lshlrev_b32 v48, 16, v18
    v_and_b32 v51, 0xffff0000, v19
    v_lshlrev_b32 v50, 16, v19
    v_and_b32 v53, 0xffff0000, v20
    v_lshlrev_b32 v52, 16, v20
    v_and_b32 v55, 0xffff0000, v21
    v_lshlrev_b32 v54, 16, v21
    v_and_b32 v57, 0xffff0000, v22
    v_lshlrev_b32 v56, 16, v22
    v_and_b32 v59, 0xffff0000, v23
    v_lshlrev_b32 v58, 16, v23
    v_and_b32 v61, 0xffff0000, v24
    v_lshlrev_b32 v60, 16, v24
    v_and_b32 v63, 0xffff0000, v25
    v_lshlrev_b32 v62, 16, v25
    v_and_b32 v65, 0xffff0000, v26
    v_lshlrev_b32 v64, 16, v26
    v_and_b32 v67, 0xffff0000, v27
    v_lshlrev_b32 v66, 16, v27
    v_and_b32 v69, 0xffff0000, v28
    v_lshlrev_b32 v68, 16, v28
    v_and_b32 v71, 0xffff0000, v29
    v_lshlrev_b32 v70, 16, v29
    v_and_b32 v73, 0xffff0000, v30
    v_lshlrev_b32 v72, 16, v30
    v_and_b32 v75, 0xffff0000, v31
    v_lshlrev_b32 v74, 16, v31
    v_and_b32 v77, 0xffff0000, v32
    v_lshlrev_b32 v76, 16, v32
    v_and_b32 v79, 0xffff0000, v33
    v_lshlrev_b32 v78, 16, v33
    v_and_b32 v81, 0xffff0000, v34
    v_lshlrev_b32 v80, 16, v34
    v_and_b32 v83, 0xffff0000, v35
    v_lshlrev_b32 v82, 16, v35
    v_and_b32 v85, 0xffff0000, v36
    v_lshlrev_b32 v84, 16, v36
    v_and_b32 v87, 0xffff0000, v37
    v_lshlrev_b32 v86, 16, v37
    v_and_b32 v89, 0xffff0000, v38
    v_lshlrev_b32 v88, 16, v38
    v_and_b32 v91, 0xffff0000, v39
    v_lshlrev_b32 v90, 16, v39
    v_and_b32 v93, 0xffff0000, v40
    v_lshlrev_b32 v92, 16, v40
    v_and_b32 v95, 0xffff0000, v41
    v_lshlrev_b32 v94, 16, v41
    v_and_b32 v97, 0xffff0000, v42
    v_lshlrev_b32 v96, 16, v42
    v_and_b32 v99, 0xffff0000, v43
    v_lshlrev_b32 v98, 16, v43
    v_pk_add_f32 v[100:101], v[44:45], v[46:47]
    v_pk_add_f32 v[102:103], v[48:49], v[50:51]
    v_pk_add_f32 v[100:101], v[100:101], v[52:53]
    v_pk_add_f32 v[102:103], v[102:103], v[54:55]
    v_pk_add_f32 v[100:101], v[100:101], v[56:57]
    v_pk_add_f32 v[102:103], v[102:103], v[58:59]
    v_pk_add_f32 v[100:101], v[100:101], v[60:61]
    v_pk_add_f32 v[102:103], v[102:103], v[62:63]
    v_pk_add_f32 v[100:101], v[100:101], v[64:65]
    v_pk_add_f32 v[102:103], v[102:103], v[66:67]
    v_pk_add_f32 v[100:101], v[100:101], v[68:69]
    v_pk_add_f32 v[102:103], v[102:103], v[70:71]
    v_pk_add_f32 v[100:101], v[100:101], v[72:73]
    v_pk_add_f32 v[102:103], v[102:103], v[74:75]
    v_pk_add_f32 v[100:101], v[100:101], v[76:77]
    v_pk_add_f32 v[102:103], v[102:103], v[78:79]
    v_pk_add_f32 v[100:101], v[100:101], v[80:81]
    v_pk_add_f32 v[102:103], v[102:103], v[82:83]
    v_pk_add_f32 v[100:101], v[100:101], v[84:85]
    v_pk_add_f32 v[102:103], v[102:103], v[86:87]
    v_pk_add_f32 v[100:101], v[100:101], v[88:89]
    v_pk_add_f32 v[102:103], v[102:103], v[90:91]
    v_pk_add_f32 v[100:101], v[100:101], v[92:93]
    v_pk_add_f32 v[102:103], v[102:103], v[94:95]
    v_pk_add_f32 v[100:101], v[100:101], v[96:97]
    v_pk_add_f32 v[102:103], v[102:103], v[98:99]
    v_pk_add_f32 v[100:101], v[100:101], v[102:103]
    v_add_f32 v100, v100, v101
    s_nop 1
    v_add_f32_dpp v100, v100, v100 row_ror:8 row_mask:0xf bank_mask:0xf
    v_mov_b32 v101, v100
    s_nop 1
    v_permlane16_swap_b32 v100, v101
    v_add_f32 v100, v100, v101
    v_mov_b32 v101, v100
    s_nop 1
    v_permlane32_swap_b32 v100, v101
    v_add_f32 v100, v100, v101
    v_mul_f32 v100, 0xbb124925, v100
    v_mov_b32 v101, v100
    v_pk_add_f32 v[104:105], v[44:45], v[100:101]
    v_pk_mul_f32 v[102:103], v[104:105], v[104:105]
    v_pk_add_f32 v[106:107], v[46:47], v[100:101]
    v_pk_fma_f32 v[102:103], v[106:107], v[106:107], v[102:103]
    v_pk_add_f32 v[104:105], v[48:49], v[100:101]
    v_pk_fma_f32 v[102:103], v[104:105], v[104:105], v[102:103]
    v_pk_add_f32 v[106:107], v[50:51], v[100:101]
    v_pk_fma_f32 v[102:103], v[106:107], v[106:107], v[102:103]
    v_pk_add_f32 v[104:105], v[52:53], v[100:101]
    v_pk_fma_f32 v[102:103], v[104:105], v[104:105], v[102:103]
    v_pk_add_f32 v[106:107], v[54:55], v[100:101]
    v_pk_fma_f32 v[102:103], v[106:107], v[106:107], v[102:103]
    v_pk_add_f32 v[104:105], v[56:57], v[100:101]
    v_pk_fma_f32 v[102:103], v[104:105], v[104:105], v[102:103]
    v_pk_add_f32 v[106:107], v[58:59], v[100:101]
    v_pk_fma_f32 v[102:103], v[106:107], v[106:107], v[102:103]
    v_pk_add_f32 v[104:105], v[60:61], v[100:101]
    v_pk_fma_f32 v[102:103], v[104:105], v[104:105], v[102:103]
    v_pk_add_f32 v[106:107], v[62:63], v[100:101]
    v_pk_fma_f32 v[102:103], v[106:107], v[106:107], v[102:103]
    v_pk_add_f32 v[104:105], v[64:65], v[100:101]
    v_pk_fma_f32 v[102:103], v[104:105], v[104:105], v[102:103]
    v_pk_add_f32 v[106:107], v[66:67], v[100:101]
    v_pk_fma_f32 v[102:103], v[106:107], v[106:107], v[102:103]
    v_pk_add_f32 v[104:105], v[68:69], v[100:101]
    v_pk_fma_f32 v[102:103], v[104:105], v[104:105], v[102:103]
    v_pk_add_f32 v[106:107], v[70:71], v[100:101]
    v_pk_fma_f32 v[102:103], v[106:107], v[106:107], v[102:103]
    v_pk_add_f32 v[104:105], v[72:73], v[100:101]
    v_pk_fma_f32 v[102:103], v[104:105], v[104:105], v[102:103]
    v_pk_add_f32 v[106:107], v[74:75], v[100:101]
    v_pk_fma_f32 v[102:103], v[106:107], v[106:107], v[102:103]
    v_pk_add_f32 v[104:105], v[76:77], v[100:101]
    v_pk_fma_f32 v[102:103], v[104:105], v[104:105], v[102:103]
    v_pk_add_f32 v[106:107], v[78:79], v[100:101]
    v_pk_fma_f32 v[102:103], v[106:107], v[106:107], v[102:103]
    v_pk_add_f32 v[104:105], v[80:81], v[100:101]
    v_pk_fma_f32 v[102:103], v[104:105], v[104:105], v[102:103]
    v_pk_add_f32 v[106:107], v[82:83], v[100:101]
    v_pk_fma_f32 v[102:103], v[106:107], v[106:107], v[102:103]
    v_pk_add_f32 v[104:105], v[84:85], v[100:101]
    v_pk_fma_f32 v[102:103], v[104:105], v[104:105], v[102:103]
    v_pk_add_f32 v[106:107], v[86:87], v[100:101]
    v_pk_fma_f32 v[102:103], v[106:107], v[106:107], v[102:103]
    v_pk_add_f32 v[104:105], v[88:89], v[100:101]
    v_pk_fma_f32 v[102:103], v[104:105], v[104:105], v[102:103]
    v_pk_add_f32 v[106:107], v[90:91], v[100:101]
    v_pk_fma_f32 v[102:103], v[106:107], v[106:107], v[102:103]
    v_pk_add_f32 v[104:105], v[92:93], v[100:101]
    v_pk_fma_f32 v[102:103], v[104:105], v[104:105], v[102:103]
    v_pk_add_f32 v[106:107], v[94:95], v[100:101]
    v_pk_fma_f32 v[102:103], v[106:107], v[106:107], v[102:103]
    v_pk_add_f32 v[104:105], v[96:97], v[100:101]
    v_pk_fma_f32 v[102:103], v[104:105], v[104:105], v[102:103]
    v_pk_add_f32 v[106:107], v[98:99], v[100:101]
    v_pk_fma_f32 v[102:103], v[106:107], v[106:107], v[102:103]
    v_add_f32 v102, v102, v103
    s_nop 1
    v_add_f32_dpp v102, v102, v102 row_ror:8 row_mask:0xf bank_mask:0xf
    v_mov_b32 v103, v102
    s_nop 1
    v_permlane16_swap_b32 v102, v103
    v_add_f32 v102, v102, v103
    v_mov_b32 v103, v102
    s_nop 1
    v_permlane32_swap_b32 v102, v103
    v_add_f32 v102, v102, v103
    v_cvt_pk_bf16_f32 v100, v100, v100
    v_and_b32 v100, 0xffff0000, v100
    v_mov_b32 v101, v100
    v_mul_f32 v102, 0x3b124925, v102
    v_cvt_pk_bf16_f32 v102, v102, v102
    v_and_b32 v102, 0xffff0000, v102
    v_add_f32 v102, 0x3727c5ac, v102
    v_cvt_pk_bf16_f32 v102, v102, v102
    v_and_b32 v102, 0xffff0000, v102
    v_sqrt_f32 v102, v102
    v_pk_add_f32 v[44:45], v[44:45], v[100:101]
    v_pk_add_f32 v[46:47], v[46:47], v[100:101]
    v_pk_add_f32 v[48:49], v[48:49], v[100:101]
    v_pk_add_f32 v[50:51], v[50:51], v[100:101]
    v_pk_add_f32 v[52:53], v[52:53], v[100:101]
    v_pk_add_f32 v[54:55], v[54:55], v[100:101]
    v_pk_add_f32 v[56:57], v[56:57], v[100:101]
    v_pk_add_f32 v[58:59], v[58:59], v[100:101]
    v_pk_add_f32 v[60:61], v[60:61], v[100:101]
    v_pk_add_f32 v[62:63], v[62:63], v[100:101]
    v_pk_add_f32 v[64:65], v[64:65], v[100:101]
    v_pk_add_f32 v[66:67], v[66:67], v[100:101]
    v_pk_add_f32 v[68:69], v[68:69], v[100:101]
    v_pk_add_f32 v[70:71], v[70:71], v[100:101]
    v_pk_add_f32 v[72:73], v[72:73], v[100:101]
    v_pk_add_f32 v[74:75], v[74:75], v[100:101]
    v_cvt_pk_bf16_f32 v102, v102, v102
    v_and_b32 v102, 0xffff0000, v102
    v_rcp_f32 v102, v102
    v_cvt_pk_bf16_f32 v16, v44, v45
    v_cvt_pk_bf16_f32 v17, v46, v47
    v_cvt_pk_bf16_f32 v18, v48, v49
    v_cvt_pk_bf16_f32 v19, v50, v51
    v_cvt_pk_bf16_f32 v20, v52, v53
    v_cvt_pk_bf16_f32 v21, v54, v55
    v_cvt_pk_bf16_f32 v22, v56, v57
    v_cvt_pk_bf16_f32 v23, v58, v59
    v_cvt_pk_bf16_f32 v24, v60, v61
    v_cvt_pk_bf16_f32 v25, v62, v63
    v_cvt_pk_bf16_f32 v26, v64, v65
    v_cvt_pk_bf16_f32 v27, v66, v67
    v_cvt_pk_bf16_f32 v28, v68, v69
    v_cvt_pk_bf16_f32 v29, v70, v71
    v_cvt_pk_bf16_f32 v30, v72, v73
    v_cvt_pk_bf16_f32 v31, v74, v75
    v_mov_b32 v103, v102
    v_and_b32 v45, 0xffff0000, v16
    v_lshlrev_b32 v44, 16, v16
    v_and_b32 v47, 0xffff0000, v17
    v_lshlrev_b32 v46, 16, v17
    v_and_b32 v49, 0xffff0000, v18
    v_lshlrev_b32 v48, 16, v18
    v_and_b32 v51, 0xffff0000, v19
    v_lshlrev_b32 v50, 16, v19
    v_and_b32 v53, 0xffff0000, v20
    v_lshlrev_b32 v52, 16, v20
    v_and_b32 v55, 0xffff0000, v21
    v_lshlrev_b32 v54, 16, v21
    v_and_b32 v57, 0xffff0000, v22
    v_lshlrev_b32 v56, 16, v22
    v_and_b32 v59, 0xffff0000, v23
    v_lshlrev_b32 v58, 16, v23
    v_and_b32 v61, 0xffff0000, v24
    v_lshlrev_b32 v60, 16, v24
    v_and_b32 v63, 0xffff0000, v25
    v_lshlrev_b32 v62, 16, v25
    v_and_b32 v65, 0xffff0000, v26
    v_lshlrev_b32 v64, 16, v26
    v_and_b32 v67, 0xffff0000, v27
    v_lshlrev_b32 v66, 16, v27
    v_and_b32 v69, 0xffff0000, v28
    v_lshlrev_b32 v68, 16, v28
    v_and_b32 v71, 0xffff0000, v29
    v_lshlrev_b32 v70, 16, v29
    v_and_b32 v73, 0xffff0000, v30
    v_lshlrev_b32 v72, 16, v30
    v_and_b32 v75, 0xffff0000, v31
    v_lshlrev_b32 v74, 16, v31
    v_pk_mul_f32 v[44:45], v[44:45], v[102:103]
    v_pk_mul_f32 v[46:47], v[46:47], v[102:103]
    v_pk_mul_f32 v[48:49], v[48:49], v[102:103]
    v_pk_mul_f32 v[50:51], v[50:51], v[102:103]
    v_pk_mul_f32 v[52:53], v[52:53], v[102:103]
    v_pk_mul_f32 v[54:55], v[54:55], v[102:103]
    v_pk_mul_f32 v[56:57], v[56:57], v[102:103]
    v_pk_mul_f32 v[58:59], v[58:59], v[102:103]
    v_pk_mul_f32 v[60:61], v[60:61], v[102:103]
    v_pk_mul_f32 v[62:63], v[62:63], v[102:103]
    v_pk_mul_f32 v[64:65], v[64:65], v[102:103]
    v_pk_mul_f32 v[66:67], v[66:67], v[102:103]
    v_pk_mul_f32 v[68:69], v[68:69], v[102:103]
    v_pk_mul_f32 v[70:71], v[70:71], v[102:103]
    v_pk_mul_f32 v[72:73], v[72:73], v[102:103]
    v_pk_mul_f32 v[74:75], v[74:75], v[102:103]
    v_cvt_pk_bf16_f32 v16, v44, v45
    v_cvt_pk_bf16_f32 v17, v46, v47
    v_cvt_pk_bf16_f32 v18, v48, v49
    v_cvt_pk_bf16_f32 v19, v50, v51
    v_cvt_pk_bf16_f32 v20, v52, v53
    v_cvt_pk_bf16_f32 v21, v54, v55
    v_cvt_pk_bf16_f32 v22, v56, v57
    v_cvt_pk_bf16_f32 v23, v58, v59
    v_cvt_pk_bf16_f32 v24, v60, v61
    v_cvt_pk_bf16_f32 v25, v62, v63
    v_cvt_pk_bf16_f32 v26, v64, v65
    v_cvt_pk_bf16_f32 v27, v66, v67
    v_cvt_pk_bf16_f32 v28, v68, v69
    v_cvt_pk_bf16_f32 v29, v70, v71
    v_cvt_pk_bf16_f32 v30, v72, v73
    v_cvt_pk_bf16_f32 v31, v74, v75
    s_waitcnt vmcnt(0)
    ds_read_b64_tr_b16 v[44:45], v12 offset:16384
    ds_read_b64_tr_b16 v[46:47], v12 offset:16896
    ds_read_b64_tr_b16 v[48:49], v12 offset:20480
    ds_read_b64_tr_b16 v[50:51], v12 offset:20992
    ds_read_b64_tr_b16 v[52:53], v12 offset:24576
    ds_read_b64_tr_b16 v[54:55], v12 offset:25088
    ds_read_b64_tr_b16 v[56:57], v12 offset:28672
    ds_read_b64_tr_b16 v[58:59], v12 offset:29184
    ds_read_b64_tr_b16 v[60:61], v12 offset:16416
    ds_read_b64_tr_b16 v[62:63], v12 offset:16928
    ds_read_b64_tr_b16 v[64:65], v12 offset:20512
    ds_read_b64_tr_b16 v[66:67], v12 offset:21024
    ds_read_b64_tr_b16 v[68:69], v12 offset:24608
    ds_read_b64_tr_b16 v[70:71], v12 offset:25120
    s_waitcnt lgkmcnt(12)
    v_mfma_f32_16x16x32_bf16 v[108:111], v[44:47], v[16:19], 0
    ds_read_b64_tr_b16 v[72:73], v12 offset:28704
    ds_read_b64_tr_b16 v[74:75], v12 offset:29216
    s_waitcnt lgkmcnt(12)
    v_mfma_f32_16x16x32_bf16 v[108:111], v[48:51], v[20:23], v[108:111]
    ds_read_b64_tr_b16 v[76:77], v12 offset:16448
    ds_read_b64_tr_b16 v[78:79], v12 offset:16960
    s_waitcnt lgkmcnt(12)
    v_mfma_f32_16x16x32_bf16 v[108:111], v[52:55], v[24:27], v[108:111]
    ds_read_b64_tr_b16 v[80:81], v12 offset:20544
    ds_read_b64_tr_b16 v[82:83], v12 offset:21056
    s_waitcnt lgkmcnt(12)
    v_mfma_f32_16x16x32_bf16 v[108:111], v[56:59], v[28:31], v[108:111]
    ds_read_b64_tr_b16 v[84:85], v12 offset:24640
    ds_read_b64_tr_b16 v[86:87], v12 offset:25152
    s_waitcnt lgkmcnt(12)
    v_mfma_f32_16x16x32_bf16 v[112:115], v[60:63], v[16:19], 0
    ds_read_b64_tr_b16 v[88:89], v12 offset:28736
    ds_read_b64_tr_b16 v[90:91], v12 offset:29248
    s_waitcnt lgkmcnt(12)
    v_mfma_f32_16x16x32_bf16 v[112:115], v[64:67], v[20:23], v[112:115]
    ds_read_b64_tr_b16 v[92:93], v12 offset:16480
    ds_read_b64_tr_b16 v[94:95], v12 offset:16992
    s_waitcnt lgkmcnt(12)
    v_mfma_f32_16x16x32_bf16 v[112:115], v[68:71], v[24:27], v[112:115]
    ds_read_b64_tr_b16 v[96:97], v12 offset:20576
    ds_read_b64_tr_b16 v[98:99], v12 offset:21088
    s_waitcnt lgkmcnt(12)
    v_mfma_f32_16x16x32_bf16 v[112:115], v[72:75], v[28:31], v[112:115]
    v_add_u32 v108, 512, v108
    v_add_u32 v109, 512, v109
    v_add_u32 v110, 512, v110
    v_add_u32 v111, 512, v111
    v_bfi_b32 v108, s82, v6, v108
    v_bfi_b32 v109, s82, v6, v109
    v_bfi_b32 v110, s82, v6, v110
    v_bfi_b32 v111, s82, v6, v111
    s_cmp_eq_u32 s87, 0
    s_cbranch_scc1 L_wt9
    buffer_store_dwordx4 v[108:111], v5, s[52:55], s70 offen offset:0
    s_branch L_we9
L_wt9:
    buffer_store_dwordx4 v[108:111], v5, s[52:55], s70 offen offset:0 sc1
L_we9:
    ds_read_b64_tr_b16 v[100:101], v12 offset:24672
    ds_read_b64_tr_b16 v[102:103], v12 offset:25184
    s_waitcnt lgkmcnt(12)
    v_mfma_f32_16x16x32_bf16 v[116:119], v[76:79], v[16:19], 0
    ds_read_b64_tr_b16 v[104:105], v12 offset:28768
    ds_read_b64_tr_b16 v[106:107], v12 offset:29280
    s_waitcnt lgkmcnt(12)
    v_mfma_f32_16x16x32_bf16 v[116:119], v[80:83], v[20:23], v[116:119]
    s_waitcnt lgkmcnt(10)
    v_mfma_f32_16x16x32_bf16 v[116:119], v[84:87], v[24:27], v[116:119]
    s_waitcnt lgkmcnt(8)
    v_mfma_f32_16x16x32_bf16 v[116:119], v[88:91], v[28:31], v[116:119]
    v_add_u32 v112, 512, v112
    v_add_u32 v113, 512, v113
    v_add_u32 v114, 512, v114
    v_add_u32 v115, 512, v115
    v_bfi_b32 v112, s82, v6, v112
    v_bfi_b32 v113, s82, v6, v113
    v_bfi_b32 v114, s82, v6, v114
    v_bfi_b32 v115, s82, v6, v115
    s_cmp_eq_u32 s87, 0
    s_cbranch_scc1 L_wt10
    buffer_store_dwordx4 v[112:115], v5, s[52:55], s70 offen offset:64
    s_branch L_we10
L_wt10:
    buffer_store_dwordx4 v[112:115], v5, s[52:55], s70 offen offset:64 sc1
L_we10:
    s_waitcnt lgkmcnt(6)
    v_mfma_f32_16x16x32_bf16 v[120:123], v[92:95], v[16:19], 0
    s_waitcnt lgkmcnt(4)
    v_mfma_f32_16x16x32_bf16 v[120:123], v[96:99], v[20:23], v[120:123]
    s_waitcnt lgkmcnt(2)
    v_mfma_f32_16x16x32_bf16 v[120:123], v[100:103], v[24:27], v[120:123]
    s_waitcnt lgkmcnt(0)
    v_mfma_f32_16x16x32_bf16 v[120:123], v[104:107], v[28:31], v[120:123]
    v_add_u32 v116, 512, v116
    v_add_u32 v117, 512, v117
    v_add_u32 v118, 512, v118
    v_add_u32 v119, 512, v119
    v_bfi_b32 v116, s82, v6, v116
    v_bfi_b32 v117, s82, v6, v117
    v_bfi_b32 v118, s82, v6, v118
    v_bfi_b32 v119, s82, v6, v119
    s_cmp_eq_u32 s87, 0
    s_cbranch_scc1 L_wt11
    buffer_store_dwordx4 v[116:119], v5, s[52:55], s70 offen offset:128
    s_branch L_we11
L_wt11:
    buffer_store_dwordx4 v[116:119], v5, s[52:55], s70 offen offset:128 sc1
L_we11:
    v_add_u32 v120, 512, v120
    v_add_u32 v121, 512, v121
    v_add_u32 v122, 512, v122
    v_add_u32 v123, 512, v123
    v_bfi_b32 v120, s82, v6, v120
    v_bfi_b32 v121, s82, v6, v121
    v_bfi_b32 v122, s82, v6, v122
    v_bfi_b32 v123, s82, v6, v123
    s_cmp_eq_u32 s87, 0
    s_cbranch_scc1 L_wt12
    buffer_store_dwordx4 v[120:123], v5, s[52:55], s70 offen offset:192
    s_branch L_we12
L_wt12:
    buffer_store_dwordx4 v[120:123], v5, s[52:55], s70 offen offset:192 sc1
L_we12:
L_noh:
    s_cmp_lt_u32 s32, 28
    s_cbranch_scc0 L_now
    v_lshrrev_b32 v1, 3, v0
    v_mul_u32_u24 v1, 896, v1
    v_and_b32 v3, 7, v0
    v_lshl_add_u32 v1, v3, 4, v1
    s_and_b32 s64, s32, 3
    s_lshl_b32 s65, s31, 2
    s_add_u32 s65, s65, s64
    v_min_u32 v3, 13, v10
    v_lshlrev_b32 v4, 12, v9
    v_lshl_add_u32 v4, v3, 4, v4
    v_lshlrev_b32 v5, 3, v3
    s_lshl_b32 s61, s31, 15
    s_mul_i32 s37, s64, 224
    s_add_u32 s61, s61, s37
    s_and_b32 s37, s31, 1
    s_lshl_b32 s37, s37, 7
    s_add_u32 s61, s61, s37
    s_add_u32 s61, s61, 589824
    s_mov_b32 s48, s18
    s_mov_b32 s49, s19
    s_mov_b32 s50, 3584
    s_mov_b32 s51, 0x20000
    s_mul_i32 s37, s65, 112
    buffer_load_dwordx2 v[20:21], v5, s[48:51], s37 offen
    s_add_u32 s60, s61, 16384
    s_mov_b32 s86, 65536
L_hp:
    buffer_load_dwordx4 v[44:47], v4, s[52:55], s61 offen offset:0 sc1
    buffer_load_dwordx4 v[48:51], v4, s[52:55], s61 offen offset:1024 sc1
    buffer_load_dwordx4 v[52:55], v4, s[52:55], s61 offen offset:2048 sc1
    buffer_load_dwordx4 v[56:59], v4, s[52:55], s61 offen offset:3072 sc1
    buffer_load_dwordx4 v[60:63], v4, s[52:55], s60 offen offset:0 sc1
    buffer_load_dwordx4 v[64:67], v4, s[52:55], s60 offen offset:1024 sc1
    buffer_load_dwordx4 v[68:71], v4, s[52:55], s60 offen offset:2048 sc1
    buffer_load_dwordx4 v[72:75], v4, s[52:55], s60 offen offset:3072 sc1
    s_waitcnt vmcnt(0)
    v_xor_b32 v44, s85, v44
    v_xor_b32 v45, s85, v45
    v_xor_b32 v46, s85, v46
    v_xor_b32 v47, s85, v47
    v_xor_b32 v48, s85, v48
    v_xor_b32 v49, s85, v49
    v_xor_b32 v50, s85, v50
    v_xor_b32 v51, s85, v51
    v_xor_b32 v52, s85, v52
    v_xor_b32 v53, s85, v53
    v_xor_b32 v54, s85, v54
    v_xor_b32 v55, s85, v55
    v_xor_b32 v56, s85, v56
    v_xor_b32 v57, s85, v57
    v_xor_b32 v58, s85, v58
    v_xor_b32 v59, s85, v59
    v_xor_b32 v60, s85, v60
    v_xor_b32 v61, s85, v61
    v_xor_b32 v62, s85, v62
    v_xor_b32 v63, s85, v63
    v_xor_b32 v64, s85, v64
    v_xor_b32 v65, s85, v65
    v_xor_b32 v66, s85, v66
    v_xor_b32 v67, s85, v67
    v_xor_b32 v68, s85, v68
    v_xor_b32 v69, s85, v69
    v_xor_b32 v70, s85, v70
    v_xor_b32 v71, s85, v71
    v_xor_b32 v72, s85, v72
    v_xor_b32 v73, s85, v73
    v_xor_b32 v74, s85, v74
    v_xor_b32 v75, s85, v75
    v_or_b32 v18, v44, v45
    v_or3_b32 v16, v46, v47, v48
    v_or3_b32 v18, v18, v49, v50
    v_or3_b32 v16, v16, v51, v52
    v_or3_b32 v18, v18, v53, v54
    v_or3_b32 v16, v16, v55, v56
    v_or3_b32 v18, v18, v57, v58
    v_or3_b32 v16, v16, v59, v60
    v_or3_b32 v18, v18, v61, v62
    v_or3_b32 v16, v16, v63, v64
    v_or3_b32 v18, v18, v65, v66
    v_or3_b32 v16, v16, v67, v68
    v_or3_b32 v18, v18, v69, v70
    v_or3_b32 v16, v16, v71, v72
    v_or3_b32 v18, v18, v73, v74
    v_or3_b32 v18, v18, v16, v75
    v_and_b32 v18, 1023, v18
    v_cmp_ne_u32 vcc, 0, v18
    s_sub_u32 s86, s86, 1
    s_cbranch_scc1 L_hpd
    s_cbranch_vccz L_hpd
    s_sleep 16
    s_branch L_hp
L_hpd:
    v_pk_add_f32 v[44:45], v[44:45], v[48:49]
    v_pk_add_f32 v[46:47], v[46:47], v[50:51]
    v_pk_add_f32 v[44:45], v[44:45], v[52:53]
    v_pk_add_f32 v[46:47], v[46:47], v[54:55]
    v_pk_add_f32 v[44:45], v[44:45], v[56:57]
    v_pk_add_f32 v[46:47], v[46:47], v[58:59]
    v_pk_add_f32 v[60:61], v[60:61], v[64:65]
    v_pk_add_f32 v[62:63], v[62:63], v[66:67]
    v_pk_add_f32 v[60:61], v[60:61], v[68:69]
    v_pk_add_f32 v[62:63], v[62:63], v[70:71]
    v_pk_add_f32 v[60:61], v[60:61], v[72:73]
    v_pk_add_f32 v[62:63], v[62:63], v[74:75]
    v_and_b32 v25, 0xffff0000, v20
    v_lshlrev_b32 v24, 16, v20
    v_and_b32 v27, 0xffff0000, v21
    v_lshlrev_b32 v26, 16, v21
    v_cvt_pk_bf16_f32 v16, v44, v45
    v_cvt_pk_bf16_f32 v17, v46, v47
    v_cvt_pk_bf16_f32 v18, v60, v61
    v_cvt_pk_bf16_f32 v19, v62, v63
    v_and_b32 v33, 0xffff0000, v16
    v_lshlrev_b32 v32, 16, v16
    v_and_b32 v35, 0xffff0000, v17
    v_lshlrev_b32 v34, 16, v17
    v_and_b32 v37, 0xffff0000, v18
    v_lshlrev_b32 v36, 16, v18
    v_and_b32 v39, 0xffff0000, v19
    v_lshlrev_b32 v38, 16, v19
    v_add_f32 v32, v32, v24
    v_add_f32 v33, v33, v25
    v_add_f32 v34, v34, v26
    v_add_f32 v35, v35, v27
    v_add_f32 v36, v36, v24
    v_add_f32 v37, v37, v25
    v_add_f32 v38, v38, v26
    v_add_f32 v39, v39, v27
    v_cvt_pk_bf16_f32 v16, v32, v33
    v_cvt_pk_bf16_f32 v17, v34, v35
    v_cvt_pk_bf16_f32 v18, v36, v37
    v_cvt_pk_bf16_f32 v19, v38, v39
    v_and_b32 v33, 0xffff0000, v16
    v_lshlrev_b32 v32, 16, v16
    v_and_b32 v35, 0xffff0000, v17
    v_lshlrev_b32 v34, 16, v17
    v_and_b32 v37, 0xffff0000, v18
    v_lshlrev_b32 v36, 16, v18
    v_and_b32 v39, 0xffff0000, v19
    v_lshlrev_b32 v38, 16, v19
    s_mov_b32 s62, 0xbdd2d3e8
    v_mov_b32 v15, 0xc0135761
    v_mul_f32 v44, v32, v32
    v_mul_f32 v45, v33, v33
    v_mul_f32 v46, v34, v34
    v_mul_f32 v47, v35, v35
    v_mul_f32 v48, v36, v36
    v_mul_f32 v49, v37, v37
    v_mul_f32 v50, v38, v38
    v_mul_f32 v51, v39, v39
    v_fma_f32 v44, v44, s62, v15
    v_fma_f32 v45, v45, s62, v15
    v_fma_f32 v46, v46, s62, v15
    v_fma_f32 v47, v47, s62, v15
    v_fma_f32 v48, v48, s62, v15
    v_fma_f32 v49, v49, s62, v15
    v_fma_f32 v50, v50, s62, v15
    v_fma_f32 v51, v51, s62, v15
    v_mul_f32 v44, v44, v32
    v_mul_f32 v45, v45, v33
    v_mul_f32 v46, v46, v34
    v_mul_f32 v47, v47, v35
    v_mul_f32 v48, v48, v36
    v_mul_f32 v49, v49, v37
    v_mul_f32 v50, v50, v38
    v_mul_f32 v51, v51, v39
    v_exp_f32 v44, v44
    v_exp_f32 v45, v45
    v_exp_f32 v46, v46
    v_exp_f32 v47, v47
    v_exp_f32 v48, v48
    v_exp_f32 v49, v49
    v_exp_f32 v50, v50
    v_exp_f32 v51, v51
    v_add_f32 v44, 1.0, v44
    v_add_f32 v45, 1.0, v45
    v_add_f32 v46, 1.0, v46
    v_add_f32 v47, 1.0, v47
    v_add_f32 v48, 1.0, v48
    v_add_f32 v49, 1.0, v49
    v_add_f32 v50, 1.0, v50
    v_add_f32 v51, 1.0, v51
    v_rcp_f32 v44, v44
    v_rcp_f32 v45, v45
    v_rcp_f32 v46, v46
    v_rcp_f32 v47, v47
    v_rcp_f32 v48, v48
    v_rcp_f32 v49, v49
    v_rcp_f32 v50, v50
    v_rcp_f32 v51, v51
    v_mul_f32 v32, v32, v44
    v_mul_f32 v33, v33, v45
    v_mul_f32 v34, v34, v46
    v_mul_f32 v35, v35, v47
    v_mul_f32 v36, v36, v48
    v_mul_f32 v37, v37, v49
    v_mul_f32 v38, v38, v50
    v_mul_f32 v39, v39, v51
    v_cmp_gt_u32 vcc, 14, v10
    v_cvt_pk_bf16_f32 v16, v32, v33
    v_cvt_pk_bf16_f32 v17, v34, v35
    v_cvt_pk_bf16_f32 v18, v36, v37
    v_cvt_pk_bf16_f32 v19, v38, v39
    v_cndmask_b32 v16, 0, v16, vcc
    v_cndmask_b32 v17, 0, v17, vcc
    v_cndmask_b32 v18, 0, v18, vcc
    v_cndmask_b32 v19, 0, v19, vcc
    v_mul_u32_u24 v3, 136, v9
    v_lshl_add_u32 v3, v10, 3, v3
    v_add_u32 v3, 79936, v3
    ds_write_b64 v3, v[16:17]
    ds_write_b64 v3, v[18:19] offset:544
L_now:
    v_and_b32 v3, 15, v0
    v_lshlrev_b32 v3, 3, v3
    v_add_u32 v3, 82048, v3
    s_mov_b32 s86, 1048576
L_mlw:
    ds_read_b64 v[16:17], v3
    s_waitcnt lgkmcnt(0)
    v_cmp_eq_u32 vcc, -1, v16
    s_sub_u32 s86, s86, 1
    s_cbranch_scc1 L_mlwd
    s_cbranch_vccz L_mlwd
    s_sleep 4
    s_branch L_mlw
L_mlwd:
    v_mov_b32 v18, v16
    s_nop 1
    v_max_f32_dpp v18, v18, v18 quad_perm:[1,0,3,2] row_mask:0xf bank_mask:0xf
    s_nop 1
    v_max_f32_dpp v18, v18, v18 quad_perm:[2,3,0,1] row_mask:0xf bank_mask:0xf
    s_nop 1
    v_max_f32_dpp v18, v18, v18 row_half_mirror row_mask:0xf bank_mask:0xf
    v_sub_f32 v20, v16, v18
    v_mul_f32 v20, s83, v20
    v_exp_f32 v20, v20
    s_nop 0
    v_mul_f32 v19, v20, v17
    s_nop 1
    v_add_f32_dpp v19, v19, v19 quad_perm:[1,0,3,2] row_mask:0xf bank_mask:0xf
    s_nop 1
    v_add_f32_dpp v19, v19, v19 quad_perm:[2,3,0,1] row_mask:0xf bank_mask:0xf
    s_nop 1
    v_add_f32_dpp v19, v19, v19 row_half_mirror row_mask:0xf bank_mask:0xf
    v_mov_b32 v20, s84
    v_mov_b32 v21, s84
    v_lshlrev_b32 v4, 1, v0
    s_mov_b32 s72, s84
    s_mov_b32 s73, s84
    s_lshl_b32 s37, s38, 7
    s_add_u32 s37, s37, 65536
    s_mov_b64 exec, 0x101
    s_cmp_eq_u32 s87, 0
    s_cbranch_scc1 L_wt13
    buffer_store_dwordx4 v[18:21], v4, s[52:55], s37 offen
    s_branch L_we13
L_wt13:
    buffer_store_dwordx4 v[18:21], v4, s[52:55], s37 offen sc1
L_we13:
    s_mov_b64 exec, -1
    s_and_b32 s61, s38, 0xfc
    s_lshl_b32 s61, s61, 7
    s_add_u32 s61, s61, 65536
    s_mov_b32 s86, 65536
    v_and_b32 v3, 3, v0
    v_lshlrev_b32 v3, 7, v3
    v_and_b32 v4, 8, v0
    v_lshl_add_u32 v3, v4, 1, v3
L_mlp2:
    s_sleep 24
    buffer_load_dwordx4 v[24:27], v3, s[52:55], s61 offen sc1
    s_waitcnt vmcnt(0)
    v_cmp_ne_u64 vcc, s[72:73], v[26:27]
    s_sub_u32 s86, s86, 1
    s_cbranch_scc1 L_mlp2d
    s_cbranch_vccnz L_mlp2
L_mlp2d:
    v_mov_b32 v28, v24
    s_nop 1
    v_max_f32_dpp v28, v28, v28 quad_perm:[1,0,3,2] row_mask:0xf bank_mask:0xf
    s_nop 1
    v_max_f32_dpp v28, v28, v28 quad_perm:[2,3,0,1] row_mask:0xf bank_mask:0xf
    v_sub_f32 v29, v24, v28
    v_mul_f32 v29, s83, v29
    v_exp_f32 v29, v29
    s_nop 0
    v_mul_f32 v29, v29, v25
    s_nop 1
    v_add_f32_dpp v29, v29, v29 quad_perm:[1,0,3,2] row_mask:0xf bank_mask:0xf
    s_nop 1
    v_add_f32_dpp v29, v29, v29 quad_perm:[2,3,0,1] row_mask:0xf bank_mask:0xf
    v_sub_f32 v30, v16, v28
    v_mul_f32 v30, s83, v30
    v_exp_f32 v30, v30
    v_rcp_f32 v29, v29
    s_nop 0
    v_mul_f32 v30, v30, v29
    v_lshlrev_b32 v3, 2, v0
    v_add_u32 v3, 82176, v3
    s_mov_b64 exec, 0xffff
    ds_write_b32 v3, v30
    s_mov_b64 exec, -1
    s_waitcnt vmcnt(0) lgkmcnt(0)
    s_endpgm
L_ctl:
    v_and_b32 v1, 7, v0
    v_lshlrev_b32 v1, 2, v1
    v_add_u32 v1, 82256, v1
    v_mov_b32 v2, 0
    ds_write_b32 v1, v2
    v_mov_b32 v3, 4
    v_mov_b32 v4, 82256
    ds_write_b32 v4, v3 offset:32
    s_waitcnt lgkmcnt(0)
    s_barrier
    s_mov_b32 s52, s28
    s_mov_b32 s53, s29
    s_mov_b32 s54, 2621440
    s_mov_b32 s55, 0x20000
    s_mov_b32 s82, 1023
    v_mov_b32 v5, 82240
    s_mov_b32 s86, 1048576
L_cq:
    ds_read_b64 v[6:7], v5
    s_waitcnt lgkmcnt(0)
    v_cmp_eq_u32 vcc, -1, v7
    s_sub_u32 s86, s86, 1
    s_cbranch_scc1 L_cqd
    s_cbranch_vccz L_cqd
    s_sleep 2
    s_branch L_cq
L_cqd:
    v_readfirstlane_b32 s84, v6
    v_readfirstlane_b32 s87, v7
    s_and_b32 s85, s84, 1023
    s_cmp_eq_u32 s87, 0
    s_cbranch_scc1 L_end
    s_lshl_b32 s61, s31, 10
    s_add_u32 s61, s61, 1900544
    s_lshl_b32 s37, s32, 5
    s_add_u32 s60, s61, s37
    v_and_b32 v8, 31, v0
    v_lshlrev_b32 v8, 5, v8
    s_mov_b32 s36, 28
    v_mov_b32 v5, 82256
    s_mov_b32 s76, 4
    s_mov_b32 s77, 0
    s_lshl_b32 s72, s31, 7
    s_add_u32 s72, s72, 1916928
    s_mov_b32 s73, 28
    s_mov_b32 s74, 35
    s_add_u32 s40, s28, 1916928
    s_addc_u32 s41, s29, 0
    v_mov_b32 v9, s84
L_ck:
    s_mov_b32 s86, 1048576
L_ckw:
    s_sleep 2
    ds_read_b32 v3, v1
    s_waitcnt lgkmcnt(0)
    v_min_u32_dpp v3, v3, v3 quad_perm:[1,0,3,2] row_mask:0xf bank_mask:0xf
    s_nop 1
    v_min_u32_dpp v3, v3, v3 quad_perm:[2,3,0,1] row_mask:0xf bank_mask:0xf
    s_nop 1
    v_min_u32_dpp v3, v3, v3 row_half_mirror row_mask:0xf bank_mask:0xf
    s_nop 0
    v_readfirstlane_b32 s37, v3
    s_sub_u32 s86, s86, 1
    s_cbranch_scc1 L_end
    s_cmp_lt_u32 s37, s36
    s_cbranch_scc1 L_ckw
    s_mov_b32 s36, s37
L_ckd:
    s_add_u32 s37, s84, s36
    v_mov_b32 v6, s37
    s_mov_b64 exec, 1
    buffer_store_dword v6, v2, s[52:55], s60 offen
    s_mov_b64 exec, 0xffffffff
    buffer_load_dword v7, v8, s[52:55], s61 offen sc1
    s_mov_b64 exec, -1
    s_cmp_lg_u32 s32, 0
    s_cbranch_scc1 L_xnp
L_xp:
    s_cmp_le_u32 s73, s36
    s_cbranch_scc0 L_xnp
    s_mov_b64 exec, 1
    buffer_store_dword v9, v2, s[52:55], s72 offen sc1
    s_mov_b64 exec, -1
    s_add_u32 s72, s72, 1024
    s_add_u32 s73, s73, 4
    s_branch L_xp
L_xnp:
    s_cmp_le_u32 s74, s36
    s_cbranch_scc0 L_xnr
L_xa:
    s_add_u32 s74, s74, 4
    s_cmp_le_u32 s74, s36
    s_cbranch_scc0 L_xr
    s_add_u32 s40, s40, 1024
    s_addc_u32 s41, s41, 0
    s_branch L_xa
L_xr:
    s_load_dword s64, s[40:41], 0
    s_load_dword s65, s[40:41], 128
    s_load_dword s66, s[40:41], 256
    s_load_dword s67, s[40:41], 384
    s_load_dword s68, s[40:41], 512
    s_load_dword s69, s[40:41], 640
    s_load_dword s70, s[40:41], 768
    s_load_dword s71, s[40:41], 896
    s_mov_b32 s37, 0
    s_waitcnt lgkmcnt(0)
    s_add_u32 s40, s40, 1024
    s_addc_u32 s41, s41, 0
    s_cmp_lg_u32 s64, s84
    s_addc_u32 s37, s37, 0
    s_cmp_lg_u32 s65, s84
    s_addc_u32 s37, s37, 0
    s_cmp_lg_u32 s66, s84
    s_addc_u32 s37, s37, 0
    s_cmp_lg_u32 s67, s84
    s_addc_u32 s37, s37, 0
    s_cmp_lg_u32 s68, s84
    s_addc_u32 s37, s37, 0
    s_cmp_lg_u32 s69, s84
    s_addc_u32 s37, s37, 0
    s_cmp_lg_u32 s70, s84
    s_addc_u32 s37, s37, 0
    s_cmp_lg_u32 s71, s84
    s_addc_u32 s37, s37, 0
    s_mov_b32 s76, 4
    s_mov_b32 s77, 0
    s_cmp_ge_u32 s37, 1
    s_cselect_b32 s76, 5, s76
    s_cselect_b32 s77, 4, s77
L_xnr:
    s_sub_u32 s62, s36, 6
    s_add_i32 s63, s36, 0
    s_add_u32 s36, s36, 2
    s_waitcnt vmcnt(0)
    v_subrev_u32 v7, s84, v7
    v_cmp_gt_u32 vcc, s62, v7
    v_cmp_lt_u32 s[64:65], s63, v7
    v_cmp_gt_u32 s[66:67], s82, v7
    s_bcnt1_i32_b32 s37, vcc_lo
    s_and_b32 s64, s64, s66
    s_bcnt1_i32_b32 s39, s64
    s_cmp_ge_u32 s39, 3
    s_cselect_b32 s39, s77, s76
    s_cmp_ge_u32 s37, 1
    s_cselect_b32 s39, 5, s39
    v_mov_b32 v6, s39
    ds_write_b32 v5, v6 offset:32
    s_cmp_le_u32 s36, 116
    s_cbranch_scc1 L_ck
    s_endpgm
L_s2:
    v_and_b32 v2, 15, v0
    v_lshlrev_b32 v2, 4, v2
    v_bfe_u32 v3, v0, 4, 1
    v_lshl_add_u32 v2, v3, 13, v2
    v_lshrrev_b32 v3, 5, v0
    v_lshl_add_u32 v2, v3, 14, v2
    s_add_u32 s44, s8, s37
    s_addc_u32 s45, s9, 0
    s_mov_b32 s46, 524288
    s_mov_b32 s47, 0x20000
    s_barrier
    s_mov_b32 s52, s28
    s_mov_b32 s53, s29
    s_mov_b32 s54, 2621440
    s_mov_b32 s55, 0x20000
    s_mov_b32 s64, 0x110011
    s_mov_b32 s65, 0x110011
    s_mov_b32 s66, 0x220022
    s_mov_b32 s67, 0x220022
    s_mov_b32 s68, 0x440044
    s_mov_b32 s69, 0x440044
    s_mov_b32 s70, 0x880088
    s_mov_b32 s71, 0x880088
    s_mov_b32 s72, 0x11001100
    s_mov_b32 s73, 0x11001100
    s_mov_b32 s74, 0x22002200
    s_mov_b32 s75, 0x22002200
    s_mov_b32 s76, 0x44004400
    s_mov_b32 s77, 0x44004400
    s_mov_b32 s78, 0x88008800
    s_mov_b32 s79, 0x88008800
    s_mov_b32 s80, 0x05040100
    s_mov_b32 s81, 0x07060302
    s_mov_b32 s62, 4
    s_lshl_b32 s37, s30, 2
    s_add_u32 s37, s37, 82256
    v_mov_b32 v163, s37
    v_mov_b32 v162, 82256
    v_min_u32 v161, 8, v0
    v_lshl_add_u32 v162, v161, 2, v162
    s_waitcnt vmcnt(2)
    buffer_load_dwordx4 v[68:71], v1, s[40:43], s36 offen offset:256 nt
    s_waitcnt vmcnt(2)
    s_xor_b32 s36, s35, 1024
    buffer_load_dwordx4 v[72:75], v1, s[40:43], s36 offen offset:0 nt
    s_waitcnt vmcnt(2)
    buffer_load_dwordx4 v[76:79], v1, s[40:43], s36 offen offset:256 nt
    s_waitcnt vmcnt(2)
    s_xor_b32 s36, s35, 1536
    buffer_load_dwordx4 v[80:83], v1, s[40:43], s36 offen offset:0 nt
    s_waitcnt vmcnt(2)
    buffer_load_dwordx4 v[84:87], v1, s[40:43], s36 offen offset:256 nt
    s_waitcnt vmcnt(2)
    s_xor_b32 s36, s35, 4096
    buffer_load_dwordx4 v[88:91], v1, s[40:43], s36 offen offset:0 nt
    s_waitcnt vmcnt(2)
    buffer_load_dwordx4 v[92:95], v1, s[40:43], s36 offen offset:256 nt
    s_waitcnt vmcnt(2)
    s_xor_b32 s36, s35, 4608
    buffer_load_dwordx4 v[96:99], v1, s[40:43], s36 offen offset:0 nt
    s_waitcnt vmcnt(2)
    buffer_load_dwordx4 v[100:103], v1, s[40:43], s36 offen offset:256 nt
    s_waitcnt vmcnt(2)
    s_xor_b32 s36, s35, 5120
    buffer_load_dwordx4 v[104:107], v1, s[40:43], s36 offen offset:0 nt
    s_waitcnt vmcnt(2)
    buffer_load_dwordx4 v[108:111], v1, s[40:43], s36 offen offset:256 nt
    s_waitcnt vmcnt(2)
    s_xor_b32 s36, s35, 5632
    buffer_load_dwordx4 v[112:115], v1, s[40:43], s36 offen offset:0 nt
    s_waitcnt vmcnt(2)
    buffer_load_dwordx4 v[116:119], v1, s[40:43], s36 offen offset:256 nt
    s_waitcnt vmcnt(2)
    s_xor_b32 s36, s35, 131072
    buffer_load_dwordx4 v[120:123], v1, s[40:43], s36 offen offset:0 nt
    s_waitcnt vmcnt(2)
    buffer_load_dwordx4 v[124:127], v1, s[40:43], s36 offen offset:256 nt
    s_waitcnt vmcnt(2)
    s_xor_b32 s36, s35, 131584
    buffer_load_dwordx4 v[128:131], v1, s[40:43], s36 offen offset:0 nt
    s_waitcnt vmcnt(2)
    buffer_load_dwordx4 v[132:135], v1, s[40:43], s36 offen offset:256 nt
    s_waitcnt vmcnt(2)
    s_xor_b32 s36, s35, 132096
    buffer_load_dwordx4 v[136:139], v1, s[40:43], s36 offen offset:0 nt
    s_waitcnt vmcnt(2)
    buffer_load_dwordx4 v[140:143], v1, s[40:43], s36 offen offset:256 nt
    s_waitcnt vmcnt(2)
    s_xor_b32 s36, s35, 132608
    buffer_load_dwordx4 v[144:147], v1, s[40:43], s36 offen offset:0 nt
    s_waitcnt vmcnt(2)
    buffer_load_dwordx4 v[148:151], v1, s[40:43], s36 offen offset:256 nt
    s_waitcnt vmcnt(2)
    s_xor_b32 s36, s35, 135168
    buffer_load_dwordx4 v[152:155], v1, s[40:43], s36 offen offset:0 nt
    s_waitcnt vmcnt(2)
    buffer_load_dwordx4 v[156:159], v1, s[40:43], s36 offen offset:256 nt
    v_bfe_u32 v3, v0, 2, 1
    v_lshlrev_b32 v3, 9, v3
    v_and_b32 v4, 3, v0
    v_lshl_add_u32 v3, v4, 4, v3
    v_lshrrev_b32 v4, 4, v0
    v_lshl_add_u32 v3, v4, 6, v3
    v_add_u32 v3, 81024, v3
    s_mov_b32 s82, 1023
    v_mov_b32 v5, 82240
    s_mov_b32 s86, 1048576
L_sq:
    ds_read_b64 v[6:7], v5
    s_waitcnt lgkmcnt(0)
    v_cmp_eq_u32 vcc, -1, v7
    s_sub_u32 s86, s86, 1
    s_cbranch_scc1 L_sqd
    s_cbranch_vccz L_sqd
    s_sleep 2
    s_branch L_sq
L_sqd:
    v_readfirstlane_b32 s84, v6
    v_readfirstlane_b32 s87, v7
    s_and_b32 s85, s84, 1023
    ds_read_b128 v[8:11], v3
    ds_read_b128 v[12:15], v3 offset:256
    v_mov_b32 v4, 0xff800000
    s_mov_b32 s83, 0x3db8aa3b
    s_waitcnt lgkmcnt(0)
    s_waitcnt vmcnt(24)
    v_mfma_f32_16x16x32_bf16 v[48:51], v[56:59], v[8:11], 0
    v_mfma_f32_16x16x32_bf16 v[48:51], v[60:63], v[12:15], v[48:51]
    s_waitcnt vmcnt(2)
    s_xor_b32 s36, s35, 135680
    buffer_load_dwordx4 v[56:59], v1, s[40:43], s36 offen offset:0 nt
    v_mfma_f32_16x16x32_bf16 v[52:55], v[64:67], v[8:11], 0
    v_mfma_f32_16x16x32_bf16 v[52:55], v[68:71], v[12:15], v[52:55]
    s_nop 2
    v_mov_b32_dpp v16, v48 quad_perm:[0,0,0,0] row_mask:0xf bank_mask:0xf
    s_nop 1
    v_add_f32_dpp v16, v49, v16 quad_perm:[1,1,1,1] row_mask:0xf bank_mask:0xf
    s_nop 1
    v_add_f32_dpp v16, v50, v16 quad_perm:[2,2,2,2] row_mask:0xf bank_mask:0xf
    s_nop 1
    v_add_f32_dpp v16, v51, v16 quad_perm:[3,3,3,3] row_mask:0xf bank_mask:0xf
    v_mfma_f32_16x16x32_bf16 v[48:51], v[72:75], v[8:11], 0
    v_mfma_f32_16x16x32_bf16 v[48:51], v[76:79], v[12:15], v[48:51]
    v_mov_b32_dpp v17, v52 quad_perm:[0,0,0,0] row_mask:0xf bank_mask:0xf
    s_nop 1
    v_add_f32_dpp v17, v53, v17 quad_perm:[1,1,1,1] row_mask:0xf bank_mask:0xf
    s_nop 1
    v_add_f32_dpp v17, v54, v17 quad_perm:[2,2,2,2] row_mask:0xf bank_mask:0xf
    s_nop 1
    v_add_f32_dpp v17, v55, v17 quad_perm:[3,3,3,3] row_mask:0xf bank_mask:0xf
    v_cvt_pk_bf16_f32 v5, v16, v17
    v_lshlrev_b32 v16, 16, v5
    v_and_b32 v17, 0xffff0000, v5
    v_max3_f32 v4, v4, v16, v17
    s_waitcnt vmcnt(2)
    buffer_load_dwordx4 v[60:63], v1, s[40:43], s36 offen offset:256 nt
    v_mfma_f32_16x16x32_bf16 v[52:55], v[80:83], v[8:11], 0
    v_mfma_f32_16x16x32_bf16 v[52:55], v[84:87], v[12:15], v[52:55]
    v_mov_b32_dpp v18, v48 quad_perm:[0,0,0,0] row_mask:0xf bank_mask:0xf
    s_nop 1
    v_add_f32_dpp v18, v49, v18 quad_perm:[1,1,1,1] row_mask:0xf bank_mask:0xf
    s_nop 1
    v_add_f32_dpp v18, v50, v18 quad_perm:[2,2,2,2] row_mask:0xf bank_mask:0xf
    s_nop 1
    v_add_f32_dpp v18, v51, v18 quad_perm:[3,3,3,3] row_mask:0xf bank_mask:0xf
    v_mfma_f32_16x16x32_bf16 v[48:51], v[88:91], v[8:11], 0
    v_mfma_f32_16x16x32_bf16 v[48:51], v[92:95], v[12:15], v[48:51]
    v_mov_b32_dpp v19, v52 quad_perm:[0,0,0,0] row_mask:0xf bank_mask:0xf
    s_nop 1
    v_add_f32_dpp v19, v53, v19 quad_perm:[1,1,1,1] row_mask:0xf bank_mask:0xf
    s_nop 1
    v_add_f32_dpp v19, v54, v19 quad_perm:[2,2,2,2] row_mask:0xf bank_mask:0xf
    s_nop 1
    v_add_f32_dpp v19, v55, v19 quad_perm:[3,3,3,3] row_mask:0xf bank_mask:0xf
    v_cvt_pk_bf16_f32 v5, v18, v19
    v_lshlrev_b32 v18, 16, v5
    v_and_b32 v19, 0xffff0000, v5
    v_max3_f32 v4, v4, v18, v19
    s_waitcnt vmcnt(2)
    s_xor_b32 s36, s35, 136192
    buffer_load_dwordx4 v[64:67], v1, s[40:43], s36 offen offset:0 nt
    v_mov_b32 v160, 28
    ds_write_b32 v163, v160
    ds_read_b32 v161, v162
    v_mfma_f32_16x16x32_bf16 v[52:55], v[96:99], v[8:11], 0
    v_mfma_f32_16x16x32_bf16 v[52:55], v[100:103], v[12:15], v[52:55]
    v_mov_b32_dpp v20, v48 quad_perm:[0,0,0,0] row_mask:0xf bank_mask:0xf
    s_nop 1
    v_add_f32_dpp v20, v49, v20 quad_perm:[1,1,1,1] row_mask:0xf bank_mask:0xf
    s_nop 1
    v_add_f32_dpp v20, v50, v20 quad_perm:[2,2,2,2] row_mask:0xf bank_mask:0xf
    s_nop 1
    v_add_f32_dpp v20, v51, v20 quad_perm:[3,3,3,3] row_mask:0xf bank_mask:0xf
    v_mfma_f32_16x16x32_bf16 v[48:51], v[104:107], v[8:11], 0
    v_mfma_f32_16x16x32_bf16 v[48:51], v[108:111], v[12:15], v[48:51]
    v_mov_b32_dpp v21, v52 quad_perm:[0,0,0,0] row_mask:0xf bank_mask:0xf
    s_nop 1
    v_add_f32_dpp v21, v53, v21 quad_perm:[1,1,1,1] row_mask:0xf bank_mask:0xf
    s_nop 1
    v_add_f32_dpp v21, v54, v21 quad_perm:[2,2,2,2] row_mask:0xf bank_mask:0xf
    s_nop 1
    v_add_f32_dpp v21, v55, v21 quad_perm:[3,3,3,3] row_mask:0xf bank_mask:0xf
    v_cvt_pk_bf16_f32 v5, v20, v21
    v_lshlrev_b32 v20, 16, v5
    v_and_b32 v21, 0xffff0000, v5
    v_max3_f32 v4, v4, v20, v21
    s_waitcnt lgkmcnt(0)
    v_cmp_gt_u32 vcc, 26, v161
    v_readlane_b32 s62, v161, 8
    s_and_b32 s37, vcc_lo, 0xff
    s_cselect_b32 s37, 5, 0
    s_or_b32 s62, s62, s37
    s_waitcnt vmcnt(2)
    buffer_load_dwordx4 v[68:71], v1, s[40:43], s36 offen offset:256 nt
    v_mov_b32 v160, 29
    ds_write_b32 v163, v160
    v_mfma_f32_16x16x32_bf16 v[52:55], v[112:115], v[8:11], 0
    v_mfma_f32_16x16x32_bf16 v[52:55], v[116:119], v[12:15], v[52:55]
    v_mov_b32_dpp v22, v48 quad_perm:[0,0,0,0] row_mask:0xf bank_mask:0xf
    s_nop 1
    v_add_f32_dpp v22, v49, v22 quad_perm:[1,1,1,1] row_mask:0xf bank_mask:0xf
    s_nop 1
    v_add_f32_dpp v22, v50, v22 quad_perm:[2,2,2,2] row_mask:0xf bank_mask:0xf
    s_nop 1
    v_add_f32_dpp v22, v51, v22 quad_perm:[3,3,3,3] row_mask:0xf bank_mask:0xf
    v_mfma_f32_16x16x32_bf16 v[48:51], v[120:123], v[8:11], 0
    v_mfma_f32_16x16x32_bf16 v[48:51], v[124:127], v[12:15], v[48:51]
    v_mov_b32_dpp v23, v52 quad_perm:[0,0,0,0] row_mask:0xf bank_mask:0xf
    s_nop 1
    v_add_f32_dpp v23, v53, v23 quad_perm:[1,1,1,1] row_mask:0xf bank_mask:0xf
    s_nop 1
    v_add_f32_dpp v23, v54, v23 quad_perm:[2,2,2,2] row_mask:0xf bank_mask:0xf
    s_nop 1
    v_add_f32_dpp v23, v55, v23 quad_perm:[3,3,3,3] row_mask:0xf bank_mask:0xf
    v_cvt_pk_bf16_f32 v5, v22, v23
    v_lshlrev_b32 v22, 16, v5
    v_and_b32 v23, 0xffff0000, v5
    v_max3_f32 v4, v4, v22, v23
    s_waitcnt vmcnt(2)
    s_bitcmp0_b32 s62, 2
    s_cbranch_scc1 L_b30
    s_waitcnt vmcnt(1)
L_b30:
    s_waitcnt vmcnt(2)
    s_xor_b32 s36, s35, 136704
    buffer_load_dwordx4 v[72:75], v1, s[40:43], s36 offen offset:0 nt
    v_mov_b32 v160, 30
    ds_write_b32 v163, v160
    ds_read_b32 v161, v162
    v_mfma_f32_16x16x32_bf16 v[52:55], v[128:131], v[8:11], 0
    v_mfma_f32_16x16x32_bf16 v[52:55], v[132:135], v[12:15], v[52:55]
    v_mov_b32_dpp v24, v48 quad_perm:[0,0,0,0] row_mask:0xf bank_mask:0xf
    s_nop 1
    v_add_f32_dpp v24, v49, v24 quad_perm:[1,1,1,1] row_mask:0xf bank_mask:0xf
    s_nop 1
    v_add_f32_dpp v24, v50, v24 quad_perm:[2,2,2,2] row_mask:0xf bank_mask:0xf
    s_nop 1
    v_add_f32_dpp v24, v51, v24 quad_perm:[3,3,3,3] row_mask:0xf bank_mask:0xf
    v_mfma_f32_16x16x32_bf16 v[48:51], v[136:139], v[8:11], 0
    v_mfma_f32_16x16x32_bf16 v[48:51], v[140:143], v[12:15], v[48:51]
    v_mov_b32_dpp v25, v52 quad_perm:[0,0,0,0] row_mask:0xf bank_mask:0xf
    s_nop 1
    v_add_f32_dpp v25, v53, v25 quad_perm:[1,1,1,1] row_mask:0xf bank_mask:0xf
    s_nop 1
    v_add_f32_dpp v25, v54, v25 quad_perm:[2,2,2,2] row_mask:0xf bank_mask:0xf
    s_nop 1
    v_add_f32_dpp v25, v55, v25 quad_perm:[3,3,3,3] row_mask:0xf bank_mask:0xf
    v_cvt_pk_bf16_f32 v5, v24, v25
    v_lshlrev_b32 v24, 16, v5
    v_and_b32 v25, 0xffff0000, v5
    v_max3_f32 v4, v4, v24, v25
    s_waitcnt lgkmcnt(0)
    v_cmp_gt_u32 vcc, 28, v161
    v_readlane_b32 s62, v161, 8
    s_and_b32 s37, vcc_lo, 0xff
    s_cselect_b32 s37, 5, 0
    s_or_b32 s62, s62, s37
    s_waitcnt vmcnt(2)
    buffer_load_dwordx4 v[76:79], v1, s[40:43], s36 offen offset:256 nt
    v_mov_b32 v160, 31
    ds_write_b32 v163, v160
    v_mfma_f32_16x16x32_bf16 v[52:55], v[144:147], v[8:11], 0
    v_mfma_f32_16x16x32_bf16 v[52:55], v[148:151], v[12:15], v[52:55]
    v_mov_b32_dpp v26, v48 quad_perm:[0,0,0,0] row_mask:0xf bank_mask:0xf
    s_nop 1
    v_add_f32_dpp v26, v49, v26 quad_perm:[1,1,1,1] row_mask:0xf bank_mask:0xf
    s_nop 1
    v_add_f32_dpp v26, v50, v26 quad_perm:[2,2,2,2] row_mask:0xf bank_mask:0xf
    s_nop 1
    v_add_f32_dpp v26, v51, v26 quad_perm:[3,3,3,3] row_mask:0xf bank_mask:0xf
    v_mfma_f32_16x16x32_bf16 v[48:51], v[152:155], v[8:11], 0
    v_mfma_f32_16x16x32_bf16 v[48:51], v[156:159], v[12:15], v[48:51]
    v_mov_b32_dpp v27, v52 quad_perm:[0,0,0,0] row_mask:0xf bank_mask:0xf
    s_nop 1
    v_add_f32_dpp v27, v53, v27 quad_perm:[1,1,1,1] row_mask:0xf bank_mask:0xf
    s_nop 1
    v_add_f32_dpp v27, v54, v27 quad_perm:[2,2,2,2] row_mask:0xf bank_mask:0xf
    s_nop 1
    v_add_f32_dpp v27, v55, v27 quad_perm:[3,3,3,3] row_mask:0xf bank_mask:0xf
    v_cvt_pk_bf16_f32 v5, v26, v27
    v_lshlrev_b32 v26, 16, v5
    v_and_b32 v27, 0xffff0000, v5
    v_max3_f32 v4, v4, v26, v27
    s_waitcnt vmcnt(2)
    s_bitcmp0_b32 s62, 0
    s_cbranch_scc1 L_b32
    s_waitcnt vmcnt(1)
L_b32:
    s_waitcnt vmcnt(2)
    s_xor_b32 s36, s35, 262144
    buffer_load_dwordx4 v[80:83], v1, s[40:43], s36 offen offset:0 nt
    v_mov_b32 v160, 32
    ds_write_b32 v163, v160
    ds_read_b32 v161, v162
    v_mfma_f32_16x16x32_bf16 v[52:55], v[56:59], v[8:11], 0
    v_mfma_f32_16x16x32_bf16 v[52:55], v[60:63], v[12:15], v[52:55]
    v_mov_b32_dpp v28, v48 quad_perm:[0,0,0,0] row_mask:0xf bank_mask:0xf
    s_nop 1
    v_add_f32_dpp v28, v49, v28 quad_perm:[1,1,1,1] row_mask:0xf bank_mask:0xf
    s_nop 1
    v_add_f32_dpp v28, v50, v28 quad_perm:[2,2,2,2] row_mask:0xf bank_mask:0xf
    s_nop 1
    v_add_f32_dpp v28, v51, v28 quad_perm:[3,3,3,3] row_mask:0xf bank_mask:0xf
    v_mfma_f32_16x16x32_bf16 v[48:51], v[64:67], v[8:11], 0
    v_mfma_f32_16x16x32_bf16 v[48:51], v[68:71], v[12:15], v[48:51]
    v_mov_b32_dpp v29, v52 quad_perm:[0,0,0,0] row_mask:0xf bank_mask:0xf
    s_nop 1
    v_add_f32_dpp v29, v53, v29 quad_perm:[1,1,1,1] row_mask:0xf bank_mask:0xf
    s_nop 1
    v_add_f32_dpp v29, v54, v29 quad_perm:[2,2,2,2] row_mask:0xf bank_mask:0xf
    s_nop 1
    v_add_f32_dpp v29, v55, v29 quad_perm:[3,3,3,3] row_mask:0xf bank_mask:0xf
    v_cvt_pk_bf16_f32 v5, v28, v29
    v_lshlrev_b32 v28, 16, v5
    v_and_b32 v29, 0xffff0000, v5
    v_max3_f32 v4, v4, v28, v29
    s_waitcnt lgkmcnt(0)
    v_cmp_gt_u32 vcc, 30, v161
    v_readlane_b32 s62, v161, 8
    s_and_b32 s37, vcc_lo, 0xff
    s_cselect_b32 s37, 5, 0
    s_or_b32 s62, s62, s37
    s_waitcnt vmcnt(2)
    buffer_load_dwordx4 v[84:87], v1, s[40:43], s36 offen offset:256 nt
    v_mov_b32 v160, 33
    ds_write_b32 v163, v160
    s_waitcnt vmcnt(2)
    s_bitcmp0_b32 s62, 2
    s_cbranch_scc1 L_b34
    s_waitcnt vmcnt(1)
L_b34:
    s_waitcnt vmcnt(2)
    s_xor_b32 s36, s35, 262656
    buffer_load_dwordx4 v[88:91], v1, s[40:43], s36 offen offset:0 nt
    v_mov_b32 v160, 34
    ds_write_b32 v163, v160
    ds_read_b32 v161, v162
    v_mfma_f32_16x16x32_bf16 v[52:55], v[72:75], v[8:11], 0
    v_mfma_f32_16x16x32_bf16 v[52:55], v[76:79], v[12:15], v[52:55]
    v_mov_b32_dpp v30, v48 quad_perm:[0,0,0,0] row_mask:0xf bank_mask:0xf
    s_nop 1
    v_add_f32_dpp v30, v49, v30 quad_perm:[1,1,1,1] row_mask:0xf bank_mask:0xf
    s_nop 1
    v_add_f32_dpp v30, v50, v30 quad_perm:[2,2,2,2] row_mask:0xf bank_mask:0xf
    s_nop 1
    v_add_f32_dpp v30, v51, v30 quad_perm:[3,3,3,3] row_mask:0xf bank_mask:0xf
    s_waitcnt lgkmcnt(0)
    v_cmp_gt_u32 vcc, 32, v161
    v_readlane_b32 s62, v161, 8
    s_and_b32 s37, vcc_lo, 0xff
    s_cselect_b32 s37, 5, 0
    s_or_b32 s62, s62, s37
    s_waitcnt vmcnt(2)
    buffer_load_dwordx4 v[92:95], v1, s[40:43], s36 offen offset:256 nt
    v_mov_b32 v160, 35
    ds_write_b32 v163, v160
    s_waitcnt vmcnt(2)
    s_bitcmp0_b32 s62, 0
    s_cbranch_scc1 L_b36
    s_waitcnt vmcnt(1)
L_b36:
    s_waitcnt vmcnt(2)
    s_xor_b32 s36, s35, 263168
    buffer_load_dwordx4 v[96:99], v1, s[40:43], s36 offen offset:0 nt
    v_mov_b32 v160, 36
    ds_write_b32 v163, v160
    ds_read_b32 v161, v162
    v_mfma_f32_16x16x32_bf16 v[48:51], v[80:83], v[8:11], 0
    v_mfma_f32_16x16x32_bf16 v[48:51], v[84:87], v[12:15], v[48:51]
    v_mov_b32_dpp v31, v52 quad_perm:[0,0,0,0] row_mask:0xf bank_mask:0xf
    s_nop 1
    v_add_f32_dpp v31, v53, v31 quad_perm:[1,1,1,1] row_mask:0xf bank_mask:0xf
    s_nop 1
    v_add_f32_dpp v31, v54, v31 quad_perm:[2,2,2,2] row_mask:0xf bank_mask:0xf
    s_nop 1
    v_add_f32_dpp v31, v55, v31 quad_perm:[3,3,3,3] row_mask:0xf bank_mask:0xf
    v_cvt_pk_bf16_f32 v5, v30, v31
    v_lshlrev_b32 v30, 16, v5
    v_and_b32 v31, 0xffff0000, v5
    v_max3_f32 v4, v4, v30, v31
    s_waitcnt lgkmcnt(0)
    v_cmp_gt_u32 vcc, 34, v161
    v_readlane_b32 s62, v161, 8
    s_and_b32 s37, vcc_lo, 0xff
    s_cselect_b32 s37, 5, 0
    s_or_b32 s62, s62, s37
    s_waitcnt vmcnt(2)
    buffer_load_dwordx4 v[100:103], v1, s[40:43], s36 offen offset:256 nt
    v_mov_b32 v160, 37
    ds_write_b32 v163, v160
    s_waitcnt vmcnt(2)
    s_bitcmp0_b32 s62, 2
    s_cbranch_scc1 L_b38
    s_waitcnt vmcnt(1)
L_b38:
    s_waitcnt vmcnt(2)
    s_xor_b32 s36, s35, 263680
    buffer_load_dwordx4 v[104:107], v1, s[40:43], s36 offen offset:0 nt
    v_mov_b32 v160, 38
    ds_write_b32 v163, v160
    ds_read_b32 v161, v162
    v_mfma_f32_16x16x32_bf16 v[52:55], v[88:91], v[8:11], 0
    v_mfma_f32_16x16x32_bf16 v[52:55], v[92:95], v[12:15], v[52:55]
    v_mov_b32_dpp v32, v48 quad_perm:[0,0,0,0] row_mask:0xf bank_mask:0xf
    s_nop 1
    v_add_f32_dpp v32, v49, v32 quad_perm:[1,1,1,1] row_mask:0xf bank_mask:0xf
    s_nop 1
    v_add_f32_dpp v32, v50, v32 quad_perm:[2,2,2,2] row_mask:0xf bank_mask:0xf
    s_nop 1
    v_add_f32_dpp v32, v51, v32 quad_perm:[3,3,3,3] row_mask:0xf bank_mask:0xf
    s_waitcnt lgkmcnt(0)
    v_cmp_gt_u32 vcc, 36, v161
    v_readlane_b32 s62, v161, 8
    s_and_b32 s37, vcc_lo, 0xff
    s_cselect_b32 s37, 5, 0
    s_or_b32 s62, s62, s37
    s_waitcnt vmcnt(2)
    buffer_load_dwordx4 v[108:111], v1, s[40:43], s36 offen offset:256 nt
    v_mov_b32 v160, 39
    ds_write_b32 v163, v160
    s_waitcnt vmcnt(2)
    s_bitcmp0_b32 s62, 0
    s_cbranch_scc1 L_b40
    s_waitcnt vmcnt(1)
L_b40:
    s_waitcnt vmcnt(2)
    s_xor_b32 s36, s35, 266240
    buffer_load_dwordx4 v[112:115], v1, s[40:43], s36 offen offset:0 nt
    v_mov_b32 v160, 40
    ds_write_b32 v163, v160
    ds_read_b32 v161, v162
    v_mfma_f32_16x16x32_bf16 v[48:51], v[96:99], v[8:11], 0
    v_mfma_f32_16x16x32_bf16 v[48:51], v[100:103], v[12:15], v[48:51]
    v_mov_b32_dpp v33, v52 quad_perm:[0,0,0,0] row_mask:0xf bank_mask:0xf
    s_nop 1
    v_add_f32_dpp v33, v53, v33 quad_perm:[1,1,1,1] row_mask:0xf bank_mask:0xf
    s_nop 1
    v_add_f32_dpp v33, v54, v33 quad_perm:[2,2,2,2] row_mask:0xf bank_mask:0xf
    s_nop 1
    v_add_f32_dpp v33, v55, v33 quad_perm:[3,3,3,3] row_mask:0xf bank_mask:0xf
    v_cvt_pk_bf16_f32 v5, v32, v33
    v_lshlrev_b32 v32, 16, v5
    v_and_b32 v33, 0xffff0000, v5
    v_max3_f32 v4, v4, v32, v33
    s_waitcnt lgkmcnt(0)
    v_cmp_gt_u32 vcc, 38, v161
    v_readlane_b32 s62, v161, 8
    s_and_b32 s37, vcc_lo, 0xff
    s_cselect_b32 s37, 5, 0
    s_or_b32 s62, s62, s37
    s_waitcnt vmcnt(2)
    buffer_load_dwordx4 v[116:119], v1, s[40:43], s36 offen offset:256 nt
    v_mov_b32 v160, 41
    ds_write_b32 v163, v160
    s_waitcnt vmcnt(2)
    s_bitcmp0_b32 s62, 2
    s_cbranch_scc1 L_b42
    s_waitcnt vmcnt(1)
L_b42:
    s_waitcnt vmcnt(2)
    s_xor_b32 s36, s35, 266752
    buffer_load_dwordx4 v[120:123], v1, s[40:43], s36 offen offset:0 nt
    v_mov_b32 v160, 42
    ds_write_b32 v163, v160
    ds_read_b32 v161, v162
    v_mfma_f32_16x16x32_bf16 v[52:55], v[104:107], v[8:11], 0
    v_mfma_f32_16x16x32_bf16 v[52:55], v[108:111], v[12:15], v[52:55]
    v_mov_b32_dpp v34, v48 quad_perm:[0,0,0,0] row_mask:0xf bank_mask:0xf
    s_nop 1
    v_add_f32_dpp v34, v49, v34 quad_perm:[1,1,1,1] row_mask:0xf bank_mask:0xf
    s_nop 1
    v_add_f32_dpp v34, v50, v34 quad_perm:[2,2,2,2] row_mask:0xf bank_mask:0xf
    s_nop 1
    v_add_f32_dpp v34, v51, v34 quad_perm:[3,3,3,3] row_mask:0xf bank_mask:0xf
    s_waitcnt lgkmcnt(0)
    v_cmp_gt_u32 vcc, 40, v161
    v_readlane_b32 s62, v161, 8
    s_and_b32 s37, vcc_lo, 0xff
    s_cselect_b32 s37, 5, 0
    s_or_b32 s62, s62, s37
    s_waitcnt vmcnt(2)
    buffer_load_dwordx4 v[124:127], v1, s[40:43], s36 offen offset:256 nt
    v_mov_b32 v160, 43
    ds_write_b32 v163, v160
    s_waitcnt vmcnt(2)
    s_bitcmp0_b32 s62, 0
    s_cbranch_scc1 L_b44
    s_waitcnt vmcnt(1)
L_b44:
    s_waitcnt vmcnt(2)
    s_xor_b32 s36, s35, 267264
    buffer_load_dwordx4 v[128:131], v1, s[40:43], s36 offen offset:0 nt
    v_mov_b32 v160, 44
    ds_write_b32 v163, v160
    ds_read_b32 v161, v162
    v_mfma_f32_16x16x32_bf16 v[48:51], v[112:115], v[8:11], 0
    v_mfma_f32_16x16x32_bf16 v[48:51], v[116:119], v[12:15], v[48:51]
    v_mov_b32_dpp v35, v52 quad_perm:[0,0,0,0] row_mask:0xf bank_mask:0xf
    s_nop 1
    v_add_f32_dpp v35, v53, v35 quad_perm:[1,1,1,1] row_mask:0xf bank_mask:0xf
    s_nop 1
    v_add_f32_dpp v35, v54, v35 quad_perm:[2,2,2,2] row_mask:0xf bank_mask:0xf
    s_nop 1
    v_add_f32_dpp v35, v55, v35 quad_perm:[3,3,3,3] row_mask:0xf bank_mask:0xf
    v_cvt_pk_bf16_f32 v5, v34, v35
    v_lshlrev_b32 v34, 16, v5
    v_and_b32 v35, 0xffff0000, v5
    v_max3_f32 v4, v4, v34, v35
    s_waitcnt lgkmcnt(0)
    v_cmp_gt_u32 vcc, 42, v161
    v_readlane_b32 s62, v161, 8
    s_and_b32 s37, vcc_lo, 0xff
    s_cselect_b32 s37, 5, 0
    s_or_b32 s62, s62, s37
    s_waitcnt vmcnt(2)
    buffer_load_dwordx4 v[132:135], v1, s[40:43], s36 offen offset:256 nt
    v_mov_b32 v160, 45
    ds_write_b32 v163, v160
    s_waitcnt vmcnt(2)
    s_bitcmp0_b32 s62, 2
    s_cbranch_scc1 L_b46
    s_waitcnt vmcnt(1)
L_b46:
    s_waitcnt vmcnt(2)
    s_xor_b32 s36, s35, 267776
    buffer_load_dwordx4 v[136:139], v1, s[40:43], s36 offen offset:0 nt
    v_mov_b32 v160, 46
    ds_write_b32 v163, v160
    ds_read_b32 v161, v162
    v_mfma_f32_16x16x32_bf16 v[52:55], v[120:123], v[8:11], 0
    v_mfma_f32_16x16x32_bf16 v[52:55], v[124:127], v[12:15], v[52:55]
    v_mov_b32_dpp v36, v48 quad_perm:[0,0,0,0] row_mask:0xf bank_mask:0xf
    s_nop 1
    v_add_f32_dpp v36, v49, v36 quad_perm:[1,1,1,1] row_mask:0xf bank_mask:0xf
    s_nop 1
    v_add_f32_dpp v36, v50, v36 quad_perm:[2,2,2,2] row_mask:0xf bank_mask:0xf
    s_nop 1
    v_add_f32_dpp v36, v51, v36 quad_perm:[3,3,3,3] row_mask:0xf bank_mask:0xf
    s_waitcnt lgkmcnt(0)
    v_cmp_gt_u32 vcc, 44, v161
    v_readlane_b32 s62, v161, 8
    s_and_b32 s37, vcc_lo, 0xff
    s_cselect_b32 s37, 5, 0
    s_or_b32 s62, s62, s37
    s_waitcnt vmcnt(2)
    buffer_load_dwordx4 v[140:143], v1, s[40:43], s36 offen offset:256 nt
    v_mov_b32 v160, 47
    ds_write_b32 v163, v160
    s_waitcnt vmcnt(2)
    s_bitcmp0_b32 s62, 0
    s_cbranch_scc1 L_b48
    s_waitcnt vmcnt(1)
L_b48:
    s_waitcnt vmcnt(2)
    s_xor_b32 s36, s35, 393216
    buffer_load_dwordx4 v[144:147], v1, s[40:43], s36 offen offset:0 nt
    v_mov_b32 v160, 48
    ds_write_b32 v163, v160
    ds_read_b32 v161, v162
    v_mfma_f32_16x16x32_bf16 v[48:51], v[128:131], v[8:11], 0
    v_mfma_f32_16x16x32_bf16 v[48:51], v[132:135], v[12:15], v[48:51]
    v_mov_b32_dpp v37, v52 quad_perm:[0,0,0,0] row_mask:0xf bank_mask:0xf
    s_nop 1
    v_add_f32_dpp v37, v53, v37 quad_perm:[1,1,1,1] row_mask:0xf bank_mask:0xf
    s_nop 1
    v_add_f32_dpp v37, v54, v37 quad_perm:[2,2,2,2] row_mask:0xf bank_mask:0xf
    s_nop 1
    v_add_f32_dpp v37, v55, v37 quad_perm:[3,3,3,3] row_mask:0xf bank_mask:0xf
    v_cvt_pk_bf16_f32 v5, v36, v37
    v_lshlrev_b32 v36, 16, v5
    v_and_b32 v37, 0xffff0000, v5
    v_max3_f32 v4, v4, v36, v37
    s_waitcnt lgkmcnt(0)
    v_cmp_gt_u32 vcc, 46, v161
    v_readlane_b32 s62, v161, 8
    s_and_b32 s37, vcc_lo, 0xff
    s_cselect_b32 s37, 5, 0
    s_or_b32 s62, s62, s37
    s_waitcnt vmcnt(2)
    buffer_load_dwordx4 v[148:151], v1, s[40:43], s36 offen offset:256 nt
    v_mov_b32 v160, 49
    ds_write_b32 v163, v160
    s_waitcnt vmcnt(2)
    s_bitcmp0_b32 s62, 2
    s_cbranch_scc1 L_b50
    s_waitcnt vmcnt(1)
L_b50:
    s_waitcnt vmcnt(2)
    s_xor_b32 s36, s35, 393728
    buffer_load_dwordx4 v[152:155], v1, s[40:43], s36 offen offset:0 nt
    v_mov_b32 v160, 50
    ds_write_b32 v163, v160
    ds_read_b32 v161, v162
    v_mfma_f32_16x16x32_bf16 v[52:55], v[136:139], v[8:11], 0
    v_mfma_f32_16x16x32_bf16 v[52:55], v[140:143], v[12:15], v[52:55]
    v_mov_b32_dpp v38, v48 quad_perm:[0,0,0,0] row_mask:0xf bank_mask:0xf
    s_nop 1
    v_add_f32_dpp v38, v49, v38 quad_perm:[1,1,1,1] row_mask:0xf bank_mask:0xf
    s_nop 1
    v_add_f32_dpp v38, v50, v38 quad_perm:[2,2,2,2] row_mask:0xf bank_mask:0xf
    s_nop 1
    v_add_f32_dpp v38, v51, v38 quad_perm:[3,3,3,3] row_mask:0xf bank_mask:0xf
    s_waitcnt lgkmcnt(0)
    v_cmp_gt_u32 vcc, 48, v161
    v_readlane_b32 s62, v161, 8
    s_and_b32 s37, vcc_lo, 0xff
    s_cselect_b32 s37, 5, 0
    s_or_b32 s62, s62, s37
    s_waitcnt vmcnt(2)
    buffer_load_dwordx4 v[156:159], v1, s[40:43], s36 offen offset:256 nt
    v_mov_b32 v160, 51
    ds_write_b32 v163, v160
    s_waitcnt vmcnt(2)
    s_bitcmp0_b32 s62, 0
    s_cbranch_scc1 L_b52
    s_waitcnt vmcnt(1)
L_b52:
    s_waitcnt vmcnt(2)
    s_xor_b32 s36, s35, 394240
    buffer_load_dwordx4 v[56:59], v1, s[40:43], s36 offen offset:0 nt
    v_mov_b32 v160, 52
    ds_write_b32 v163, v160
    ds_read_b32 v161, v162
    v_mfma_f32_16x16x32_bf16 v[48:51], v[144:147], v[8:11], 0
    v_mfma_f32_16x16x32_bf16 v[48:51], v[148:151], v[12:15], v[48:51]
    v_mov_b32_dpp v39, v52 quad_perm:[0,0,0,0] row_mask:0xf bank_mask:0xf
    s_nop 1
    v_add_f32_dpp v39, v53, v39 quad_perm:[1,1,1,1] row_mask:0xf bank_mask:0xf
    s_nop 1
    v_add_f32_dpp v39, v54, v39 quad_perm:[2,2,2,2] row_mask:0xf bank_mask:0xf
    s_nop 1
    v_add_f32_dpp v39, v55, v39 quad_perm:[3,3,3,3] row_mask:0xf bank_mask:0xf
    v_cvt_pk_bf16_f32 v5, v38, v39
    v_lshlrev_b32 v38, 16, v5
    v_and_b32 v39, 0xffff0000, v5
    v_max3_f32 v4, v4, v38, v39
    s_waitcnt lgkmcnt(0)
    v_cmp_gt_u32 vcc, 50, v161
    v_readlane_b32 s62, v161, 8
    s_and_b32 s37, vcc_lo, 0xff
    s_cselect_b32 s37, 5, 0
    s_or_b32 s62, s62, s37
    s_waitcnt vmcnt(2)
    buffer_load_dwordx4 v[60:63], v1, s[40:43], s36 offen offset:256 nt
    v_mov_b32 v160, 53
    ds_write_b32 v163, v160
    s_waitcnt vmcnt(2)
    s_bitcmp0_b32 s62, 2
    s_cbranch_scc1 L_b54
    s_waitcnt vmcnt(1)
L_b54:
    s_waitcnt vmcnt(2)
    s_xor_b32 s36, s35, 394752
    buffer_load_dwordx4 v[64:67], v1, s[40:43], s36 offen offset:0 nt
    v_mov_b32 v160, 54
    ds_write_b32 v163, v160
    ds_read_b32 v161, v162
    v_mfma_f32_16x16x32_bf16 v[52:55], v[152:155], v[8:11], 0
    v_mfma_f32_16x16x32_bf16 v[52:55], v[156:159], v[12:15], v[52:55]
    v_mov_b32_dpp v40, v48 quad_perm:[0,0,0,0] row_mask:0xf bank_mask:0xf
    s_nop 1
    v_add_f32_dpp v40, v49, v40 quad_perm:[1,1,1,1] row_mask:0xf bank_mask:0xf
    s_nop 1
    v_add_f32_dpp v40, v50, v40 quad_perm:[2,2,2,2] row_mask:0xf bank_mask:0xf
    s_nop 1
    v_add_f32_dpp v40, v51, v40 quad_perm:[3,3,3,3] row_mask:0xf bank_mask:0xf
    s_waitcnt lgkmcnt(0)
    v_cmp_gt_u32 vcc, 52, v161
    v_readlane_b32 s62, v161, 8
    s_and_b32 s37, vcc_lo, 0xff
    s_cselect_b32 s37, 5, 0
    s_or_b32 s62, s62, s37
    s_waitcnt vmcnt(2)
    buffer_load_dwordx4 v[68:71], v1, s[40:43], s36 offen offset:256 nt
    v_mov_b32 v160, 55
    ds_write_b32 v163, v160
    s_waitcnt vmcnt(2)
    s_bitcmp0_b32 s62, 0
    s_cbranch_scc1 L_b56
    s_waitcnt vmcnt(1)
L_b56:
    s_waitcnt vmcnt(2)
    s_xor_b32 s36, s35, 397312
    buffer_load_dwordx4 v[72:75], v1, s[40:43], s36 offen offset:0 nt
    v_mov_b32 v160, 56
    ds_write_b32 v163, v160
    ds_read_b32 v161, v162
    v_mfma_f32_16x16x32_bf16 v[48:51], v[56:59], v[8:11], 0
    v_mfma_f32_16x16x32_bf16 v[48:51], v[60:63], v[12:15], v[48:51]
    v_mov_b32_dpp v41, v52 quad_perm:[0,0,0,0] row_mask:0xf bank_mask:0xf
    s_nop 1
    v_add_f32_dpp v41, v53, v41 quad_perm:[1,1,1,1] row_mask:0xf bank_mask:0xf
    s_nop 1
    v_add_f32_dpp v41, v54, v41 quad_perm:[2,2,2,2] row_mask:0xf bank_mask:0xf
    s_nop 1
    v_add_f32_dpp v41, v55, v41 quad_perm:[3,3,3,3] row_mask:0xf bank_mask:0xf
    v_cvt_pk_bf16_f32 v5, v40, v41
    v_lshlrev_b32 v40, 16, v5
    v_and_b32 v41, 0xffff0000, v5
    v_max3_f32 v4, v4, v40, v41
    s_waitcnt lgkmcnt(0)
    v_cmp_gt_u32 vcc, 54, v161
    v_readlane_b32 s62, v161, 8
    s_and_b32 s37, vcc_lo, 0xff
    s_cselect_b32 s37, 5, 0
    s_or_b32 s62, s62, s37
    s_waitcnt vmcnt(2)
    buffer_load_dwordx4 v[76:79], v1, s[40:43], s36 offen offset:256 nt
    v_mov_b32 v160, 57
    ds_write_b32 v163, v160
    s_waitcnt vmcnt(2)
    s_bitcmp0_b32 s62, 2
    s_cbranch_scc1 L_b58
    s_waitcnt vmcnt(1)
L_b58:
    s_waitcnt vmcnt(2)
    s_xor_b32 s36, s35, 397824
    buffer_load_dwordx4 v[80:83], v1, s[40:43], s36 offen offset:0 nt
    v_mov_b32 v160, 58
    ds_write_b32 v163, v160
    ds_read_b32 v161, v162
    v_mfma_f32_16x16x32_bf16 v[52:55], v[64:67], v[8:11], 0
    v_mfma_f32_16x16x32_bf16 v[52:55], v[68:71], v[12:15], v[52:55]
    v_mov_b32_dpp v42, v48 quad_perm:[0,0,0,0] row_mask:0xf bank_mask:0xf
    s_nop 1
    v_add_f32_dpp v42, v49, v42 quad_perm:[1,1,1,1] row_mask:0xf bank_mask:0xf
    s_nop 1
    v_add_f32_dpp v42, v50, v42 quad_perm:[2,2,2,2] row_mask:0xf bank_mask:0xf
    s_nop 1
    v_add_f32_dpp v42, v51, v42 quad_perm:[3,3,3,3] row_mask:0xf bank_mask:0xf
    s_waitcnt lgkmcnt(0)
    v_cmp_gt_u32 vcc, 56, v161
    v_readlane_b32 s62, v161, 8
    s_and_b32 s37, vcc_lo, 0xff
    s_cselect_b32 s37, 5, 0
    s_or_b32 s62, s62, s37
    s_waitcnt vmcnt(2)
    buffer_load_dwordx4 v[84:87], v1, s[40:43], s36 offen offset:256 nt
    v_mov_b32 v160, 59
    ds_write_b32 v163, v160
    s_waitcnt vmcnt(2)
    s_bitcmp0_b32 s62, 0
    s_cbranch_scc1 L_b60
    s_waitcnt vmcnt(1)
L_b60:
    s_waitcnt vmcnt(2)
    s_xor_b32 s36, s35, 398336
    buffer_load_dwordx4 v[88:91], v1, s[40:43], s36 offen offset:0 nt
    v_mov_b32 v160, 60
    ds_write_b32 v163, v160
    ds_read_b32 v161, v162
    v_mfma_f32_16x16x32_bf16 v[48:51], v[72:75], v[8:11], 0
    v_mfma_f32_16x16x32_bf16 v[48:51], v[76:79], v[12:15], v[48:51]
    v_mov_b32_dpp v43, v52 quad_perm:[0,0,0,0] row_mask:0xf bank_mask:0xf
    s_nop 1
    v_add_f32_dpp v43, v53, v43 quad_perm:[1,1,1,1] row_mask:0xf bank_mask:0xf
    s_nop 1
    v_add_f32_dpp v43, v54, v43 quad_perm:[2,2,2,2] row_mask:0xf bank_mask:0xf
    s_nop 1
    v_add_f32_dpp v43, v55, v43 quad_perm:[3,3,3,3] row_mask:0xf bank_mask:0xf
    v_cvt_pk_bf16_f32 v5, v42, v43
    v_lshlrev_b32 v42, 16, v5
    v_and_b32 v43, 0xffff0000, v5
    v_max3_f32 v4, v4, v42, v43
    s_waitcnt lgkmcnt(0)
    v_cmp_gt_u32 vcc, 58, v161
    v_readlane_b32 s62, v161, 8
    s_and_b32 s37, vcc_lo, 0xff
    s_cselect_b32 s37, 5, 0
    s_or_b32 s62, s62, s37
    s_waitcnt vmcnt(2)
    buffer_load_dwordx4 v[92:95], v1, s[40:43], s36 offen offset:256 nt
    v_mov_b32 v160, 61
    ds_write_b32 v163, v160
    s_waitcnt vmcnt(2)
    s_bitcmp0_b32 s62, 2
    s_cbranch_scc1 L_b62
    s_waitcnt vmcnt(1)
L_b62:
    s_waitcnt vmcnt(2)
    s_xor_b32 s36, s35, 398848
    buffer_load_dwordx4 v[96:99], v1, s[40:43], s36 offen offset:0 nt
    v_mov_b32 v160, 62
    ds_write_b32 v163, v160
    ds_read_b32 v161, v162
    v_mfma_f32_16x16x32_bf16 v[52:55], v[80:83], v[8:11], 0
    v_mfma_f32_16x16x32_bf16 v[52:55], v[84:87], v[12:15], v[52:55]
    v_mov_b32_dpp v44, v48 quad_perm:[0,0,0,0] row_mask:0xf bank_mask:0xf
    s_nop 1
    v_add_f32_dpp v44, v49, v44 quad_perm:[1,1,1,1] row_mask:0xf bank_mask:0xf
    s_nop 1
    v_add_f32_dpp v44, v50, v44 quad_perm:[2,2,2,2] row_mask:0xf bank_mask:0xf
    s_nop 1
    v_add_f32_dpp v44, v51, v44 quad_perm:[3,3,3,3] row_mask:0xf bank_mask:0xf
    s_waitcnt lgkmcnt(0)
    v_cmp_gt_u32 vcc, 60, v161
    v_readlane_b32 s62, v161, 8
    s_and_b32 s37, vcc_lo, 0xff
    s_cselect_b32 s37, 5, 0
    s_or_b32 s62, s62, s37
    s_waitcnt vmcnt(2)
    buffer_load_dwordx4 v[100:103], v1, s[40:43], s36 offen offset:256 nt
    v_mov_b32 v160, 63
    ds_write_b32 v163, v160
    s_waitcnt vmcnt(2)
    s_bitcmp0_b32 s62, 0
    s_cbranch_scc1 L_b64
    s_waitcnt vmcnt(1)
L_b64:
    s_waitcnt vmcnt(2)
    s_xor_b32 s36, s35, 0
    buffer_load_dwordx4 v[104:107], v2, s[44:47], s36 offen offset:0 nt
    v_mov_b32 v160, 64
    ds_write_b32 v163, v160
    ds_read_b32 v161, v162
    v_mfma_f32_16x16x32_bf16 v[48:51], v[88:91], v[8:11], 0
    v_mfma_f32_16x16x32_bf16 v[48:51], v[92:95], v[12:15], v[48:51]
    v_mov_b32_dpp v45, v52 quad_perm:[0,0,0,0] row_mask:0xf bank_mask:0xf
    s_nop 1
    v_add_f32_dpp v45, v53, v45 quad_perm:[1,1,1,1] row_mask:0xf bank_mask:0xf
    s_nop 1
    v_add_f32_dpp v45, v54, v45 quad_perm:[2,2,2,2] row_mask:0xf bank_mask:0xf
    s_nop 1
    v_add_f32_dpp v45, v55, v45 quad_perm:[3,3,3,3] row_mask:0xf bank_mask:0xf
    v_cvt_pk_bf16_f32 v5, v44, v45
    v_lshlrev_b32 v44, 16, v5
    v_and_b32 v45, 0xffff0000, v5
    v_max3_f32 v4, v4, v44, v45
    s_waitcnt lgkmcnt(0)
    v_cmp_gt_u32 vcc, 62, v161
    v_readlane_b32 s62, v161, 8
    s_and_b32 s37, vcc_lo, 0xff
    s_cselect_b32 s37, 5, 0
    s_or_b32 s62, s62, s37
    s_waitcnt vmcnt(2)
    buffer_load_dwordx4 v[108:111], v2, s[44:47], s36 offen offset:256 nt
    v_mov_b32 v160, 65
    ds_write_b32 v163, v160
    s_waitcnt vmcnt(2)
    s_bitcmp0_b32 s62, 2
    s_cbranch_scc1 L_b66
    s_waitcnt vmcnt(1)
L_b66:
    s_waitcnt vmcnt(2)
    s_xor_b32 s36, s35, 512
    buffer_load_dwordx4 v[112:115], v2, s[44:47], s36 offen offset:0 nt
    v_mov_b32 v160, 66
    ds_write_b32 v163, v160
    ds_read_b32 v161, v162
    v_mfma_f32_16x16x32_bf16 v[52:55], v[96:99], v[8:11], 0
    v_mfma_f32_16x16x32_bf16 v[52:55], v[100:103], v[12:15], v[52:55]
    v_mov_b32_dpp v46, v48 quad_perm:[0,0,0,0] row_mask:0xf bank_mask:0xf
    s_nop 1
    v_add_f32_dpp v46, v49, v46 quad_perm:[1,1,1,1] row_mask:0xf bank_mask:0xf
    s_nop 1
    v_add_f32_dpp v46, v50, v46 quad_perm:[2,2,2,2] row_mask:0xf bank_mask:0xf
    s_nop 1
    v_add_f32_dpp v46, v51, v46 quad_perm:[3,3,3,3] row_mask:0xf bank_mask:0xf
    v_mov_b32_dpp v47, v52 quad_perm:[0,0,0,0] row_mask:0xf bank_mask:0xf
    s_nop 1
    v_add_f32_dpp v47, v53, v47 quad_perm:[1,1,1,1] row_mask:0xf bank_mask:0xf
    s_nop 1
    v_add_f32_dpp v47, v54, v47 quad_perm:[2,2,2,2] row_mask:0xf bank_mask:0xf
    s_nop 1
    v_add_f32_dpp v47, v55, v47 quad_perm:[3,3,3,3] row_mask:0xf bank_mask:0xf
    v_cvt_pk_bf16_f32 v5, v46, v47
    v_lshlrev_b32 v46, 16, v5
    v_and_b32 v47, 0xffff0000, v5
    v_max3_f32 v4, v4, v46, v47
    v_mov_b32 v5, v4
    s_nop 1
    v_permlane16_swap_b32 v4, v5
    v_max_f32 v4, v4, v5
    v_mov_b32 v5, v4
    s_nop 1
    v_permlane32_swap_b32 v4, v5
    v_max_f32 v4, v4, v5
    v_mul_f32 v6, s83, v4
    v_mov_b32 v7, 0
    s_waitcnt lgkmcnt(0)
    v_cmp_gt_u32 vcc, 64, v161
    v_readlane_b32 s62, v161, 8
    s_and_b32 s37, vcc_lo, 0xff
    s_cselect_b32 s37, 5, 0
    s_or_b32 s62, s62, s37
    s_waitcnt vmcnt(2)
    buffer_load_dwordx4 v[116:119], v2, s[44:47], s36 offen offset:256 nt
    v_mov_b32 v160, 67
    ds_write_b32 v163, v160
    v_fma_f32 v16, v16, s83, -v6
    v_fma_f32 v17, v17, s83, -v6
    v_fma_f32 v18, v18, s83, -v6
    v_fma_f32 v19, v19, s83, -v6
    v_fma_f32 v20, v20, s83, -v6
    v_fma_f32 v21, v21, s83, -v6
    v_fma_f32 v22, v22, s83, -v6
    v_fma_f32 v23, v23, s83, -v6
    v_exp_f32 v16, v16
    v_exp_f32 v17, v17
    v_exp_f32 v18, v18
    v_exp_f32 v19, v19
    v_exp_f32 v20, v20
    v_exp_f32 v21, v21
    v_exp_f32 v22, v22
    v_exp_f32 v23, v23
    v_add_f32 v7, v7, v16
    v_add_f32 v7, v7, v17
    v_add_f32 v7, v7, v18
    v_add_f32 v7, v7, v19
    v_add_f32 v7, v7, v20
    v_add_f32 v7, v7, v21
    v_add_f32 v7, v7, v22
    v_add_f32 v7, v7, v23
    v_cvt_pk_bf16_f32 v16, v16, v17
    v_cvt_pk_bf16_f32 v17, v18, v19
    v_cvt_pk_bf16_f32 v18, v20, v21
    v_cvt_pk_bf16_f32 v19, v22, v23
    v_fma_f32 v24, v24, s83, -v6
    v_fma_f32 v25, v25, s83, -v6
    v_fma_f32 v26, v26, s83, -v6
    v_fma_f32 v27, v27, s83, -v6
    v_fma_f32 v28, v28, s83, -v6
    v_fma_f32 v29, v29, s83, -v6
    v_fma_f32 v30, v30, s83, -v6
    v_fma_f32 v31, v31, s83, -v6
    v_exp_f32 v24, v24
    v_exp_f32 v25, v25
    v_exp_f32 v26, v26
    v_exp_f32 v27, v27
    v_exp_f32 v28, v28
    v_exp_f32 v29, v29
    v_exp_f32 v30, v30
    v_exp_f32 v31, v31
    v_add_f32 v7, v7, v24
    v_add_f32 v7, v7, v25
    v_add_f32 v7, v7, v26
    v_add_f32 v7, v7, v27
    v_add_f32 v7, v7, v28
    v_add_f32 v7, v7, v29
    v_add_f32 v7, v7, v30
    v_add_f32 v7, v7, v31
    v_cvt_pk_bf16_f32 v20, v24, v25
    v_cvt_pk_bf16_f32 v21, v26, v27
    v_cvt_pk_bf16_f32 v22, v28, v29
    v_cvt_pk_bf16_f32 v23, v30, v31
    s_waitcnt vmcnt(2)
    s_bitcmp0_b32 s62, 0
    s_cbranch_scc1 L_b68
    s_waitcnt vmcnt(1)
L_b68:
    s_waitcnt vmcnt(2)
    s_xor_b32 s36, s35, 1024
    buffer_load_dwordx4 v[120:123], v2, s[44:47], s36 offen offset:0 nt
    v_mov_b32 v160, 68
    ds_write_b32 v163, v160
    ds_read_b32 v161, v162
    v_fma_f32 v32, v32, s83, -v6
    v_fma_f32 v33, v33, s83, -v6
    v_fma_f32 v34, v34, s83, -v6
    v_fma_f32 v35, v35, s83, -v6
    v_fma_f32 v36, v36, s83, -v6
    v_fma_f32 v37, v37, s83, -v6
    v_fma_f32 v38, v38, s83, -v6
    v_fma_f32 v39, v39, s83, -v6
    v_exp_f32 v32, v32
    v_exp_f32 v33, v33
    v_exp_f32 v34, v34
    v_exp_f32 v35, v35
    v_exp_f32 v36, v36
    v_exp_f32 v37, v37
    v_exp_f32 v38, v38
    v_exp_f32 v39, v39
    v_add_f32 v7, v7, v32
    v_add_f32 v7, v7, v33
    v_add_f32 v7, v7, v34
    v_add_f32 v7, v7, v35
    v_add_f32 v7, v7, v36
    v_add_f32 v7, v7, v37
    v_add_f32 v7, v7, v38
    v_add_f32 v7, v7, v39
    v_cvt_pk_bf16_f32 v24, v32, v33
    v_cvt_pk_bf16_f32 v25, v34, v35
    v_cvt_pk_bf16_f32 v26, v36, v37
    v_cvt_pk_bf16_f32 v27, v38, v39
    v_fma_f32 v40, v40, s83, -v6
    v_fma_f32 v41, v41, s83, -v6
    v_fma_f32 v42, v42, s83, -v6
    v_fma_f32 v43, v43, s83, -v6
    v_fma_f32 v44, v44, s83, -v6
    v_fma_f32 v45, v45, s83, -v6
    v_fma_f32 v46, v46, s83, -v6
    v_fma_f32 v47, v47, s83, -v6
    v_exp_f32 v40, v40
    v_exp_f32 v41, v41
    v_exp_f32 v42, v42
    v_exp_f32 v43, v43
    v_exp_f32 v44, v44
    v_exp_f32 v45, v45
    v_exp_f32 v46, v46
    v_exp_f32 v47, v47
    v_add_f32 v7, v7, v40
    v_add_f32 v7, v7, v41
    v_add_f32 v7, v7, v42
    v_add_f32 v7, v7, v43
    v_add_f32 v7, v7, v44
    v_add_f32 v7, v7, v45
    v_add_f32 v7, v7, v46
    v_add_f32 v7, v7, v47
    v_cvt_pk_bf16_f32 v28, v40, v41
    v_cvt_pk_bf16_f32 v29, v42, v43
    v_cvt_pk_bf16_f32 v30, v44, v45
    v_cvt_pk_bf16_f32 v31, v46, v47
    s_waitcnt lgkmcnt(0)
    v_cmp_gt_u32 vcc, 66, v161
    v_readlane_b32 s62, v161, 8
    s_and_b32 s37, vcc_lo, 0xff
    s_cselect_b32 s37, 5, 0
    s_or_b32 s62, s62, s37
    s_waitcnt vmcnt(2)
    buffer_load_dwordx4 v[124:127], v2, s[44:47], s36 offen offset:256 nt
    v_mov_b32 v160, 69
    ds_write_b32 v163, v160
    v_mov_b32 v5, v7
    s_nop 1
    v_permlane16_swap_b32 v7, v5
    v_add_f32 v7, v7, v5
    v_mov_b32 v5, v7
    s_nop 1
    v_permlane32_swap_b32 v7, v5
    v_add_f32 v7, v7, v5
    v_mov_b32 v5, v7
    v_bfe_u32 v3, v0, 2, 1
    v_lshlrev_b32 v3, 6, v3
    s_lshl_b32 s37, s30, 3
    s_add_u32 s37, s37, 82048
    v_add_u32 v3, s37, v3
    s_mov_b64 exec, 0x11
    ds_write_b64 v3, v[4:5]
    s_mov_b64 exec, -1
    s_waitcnt vmcnt(2)
    s_bitcmp0_b32 s62, 2
    s_cbranch_scc1 L_b70
    s_waitcnt vmcnt(1)
L_b70:
    s_waitcnt vmcnt(2)
    s_xor_b32 s36, s35, 1536
    buffer_load_dwordx4 v[128:131], v2, s[44:47], s36 offen offset:0 nt
    v_mov_b32 v160, 70
    ds_write_b32 v163, v160
    ds_read_b32 v161, v162
    s_waitcnt lgkmcnt(0)
    v_cmp_gt_u32 vcc, 68, v161
    v_readlane_b32 s62, v161, 8
    s_and_b32 s37, vcc_lo, 0xff
    s_cselect_b32 s37, 5, 0
    s_or_b32 s62, s62, s37
    s_waitcnt vmcnt(2)
    buffer_load_dwordx4 v[132:135], v2, s[44:47], s36 offen offset:256 nt
    v_mov_b32 v160, 71
    ds_write_b32 v163, v160
    s_waitcnt vmcnt(2)
    s_bitcmp0_b32 s62, 0
    s_cbranch_scc1 L_b72
    s_waitcnt vmcnt(1)
L_b72:
    s_waitcnt vmcnt(2)
    s_xor_b32 s36, s35, 4096
    buffer_load_dwordx4 v[136:139], v2, s[44:47], s36 offen offset:0 nt
    v_mov_b32 v160, 72
    ds_write_b32 v163, v160
    ds_read_b32 v161, v162
    s_waitcnt lgkmcnt(0)
    v_cmp_gt_u32 vcc, 70, v161
    v_readlane_b32 s62, v161, 8
    s_and_b32 s37, vcc_lo, 0xff
    s_cselect_b32 s37, 5, 0
    s_or_b32 s62, s62, s37
    s_waitcnt vmcnt(2)
    buffer_load_dwordx4 v[140:143], v2, s[44:47], s36 offen offset:256 nt
    v_mov_b32 v160, 73
    ds_write_b32 v163, v160
    s_waitcnt vmcnt(2)
    s_bitcmp0_b32 s62, 2
    s_cbranch_scc1 L_b74
    s_waitcnt vmcnt(1)
L_b74:
    s_waitcnt vmcnt(2)
    s_xor_b32 s36, s35, 4608
    buffer_load_dwordx4 v[144:147], v2, s[44:47], s36 offen offset:0 nt
    v_mov_b32 v160, 74
    ds_write_b32 v163, v160
    ds_read_b32 v161, v162
    s_waitcnt lgkmcnt(0)
    v_cmp_gt_u32 vcc, 72, v161
    v_readlane_b32 s62, v161, 8
    s_and_b32 s37, vcc_lo, 0xff
    s_cselect_b32 s37, 5, 0
    s_or_b32 s62, s62, s37
    s_waitcnt vmcnt(2)
    buffer_load_dwordx4 v[148:151], v2, s[44:47], s36 offen offset:256 nt
    v_mov_b32 v160, 75
    ds_write_b32 v163, v160
    s_waitcnt vmcnt(2)
    s_bitcmp0_b32 s62, 0
    s_cbranch_scc1 L_b76
    s_waitcnt vmcnt(1)
L_b76:
    s_waitcnt vmcnt(2)
    s_xor_b32 s36, s35, 5120
    buffer_load_dwordx4 v[152:155], v2, s[44:47], s36 offen offset:0 nt
    v_mov_b32 v160, 76
    ds_write_b32 v163, v160
    ds_read_b32 v161, v162
    s_waitcnt lgkmcnt(0)
    v_cmp_gt_u32 vcc, 74, v161
    v_readlane_b32 s62, v161, 8
    s_and_b32 s37, vcc_lo, 0xff
    s_cselect_b32 s37, 5, 0
    s_or_b32 s62, s62, s37
    s_waitcnt vmcnt(2)
    buffer_load_dwordx4 v[156:159], v2, s[44:47], s36 offen offset:256 nt
    v_mov_b32 v160, 77
    ds_write_b32 v163, v160
    s_waitcnt vmcnt(2)
    s_bitcmp0_b32 s62, 2
    s_cbranch_scc1 L_b78
    s_waitcnt vmcnt(1)
L_b78:
    s_waitcnt vmcnt(2)
    s_xor_b32 s36, s35, 5632
    buffer_load_dwordx4 v[56:59], v2, s[44:47], s36 offen offset:0 nt
    v_mov_b32 v160, 78
    ds_write_b32 v163, v160
    ds_read_b32 v161, v162
    s_waitcnt lgkmcnt(0)
    v_cmp_gt_u32 vcc, 76, v161
    v_readlane_b32 s62, v161, 8
    s_and_b32 s37, vcc_lo, 0xff
    s_cselect_b32 s37, 5, 0
    s_or_b32 s62, s62, s37
    s_waitcnt vmcnt(2)
    buffer_load_dwordx4 v[60:63], v2, s[44:47], s36 offen offset:256 nt
    v_mov_b32 v160, 79
    ds_write_b32 v163, v160
    s_waitcnt vmcnt(2)
    s_bitcmp0_b32 s62, 0
    s_cbranch_scc1 L_b80
    s_waitcnt vmcnt(1)
L_b80:
    s_waitcnt vmcnt(2)
    s_xor_b32 s36, s35, 131072
    buffer_load_dwordx4 v[64:67], v2, s[44:47], s36 offen offset:0 nt
    v_mov_b32 v160, 80
    ds_write_b32 v163, v160
    ds_read_b32 v161, v162
    s_waitcnt lgkmcnt(0)
    v_cmp_gt_u32 vcc, 78, v161
    v_readlane_b32 s62, v161, 8
    s_and_b32 s37, vcc_lo, 0xff
    s_cselect_b32 s37, 5, 0
    s_or_b32 s62, s62, s37
    s_waitcnt vmcnt(2)
    buffer_load_dwordx4 v[68:71], v2, s[44:47], s36 offen offset:256 nt
    v_mov_b32 v160, 81
    ds_write_b32 v163, v160
    v_cndmask_b32 v32, 0, v16, s[64:65]
    v_cndmask_b32 v33, 0, v17, s[64:65]
    v_cndmask_b32 v34, 0, v18, s[64:65]
    v_cndmask_b32 v35, 0, v19, s[64:65]
    v_perm_b32 v40, v112, v104, s80
    v_perm_b32 v41, v128, v120, s80
    v_perm_b32 v42, v144, v136, s80
    v_perm_b32 v43, v56, v152, s80
    s_nop 1
    v_mfma_f32_16x16x32_bf16 v[48:51], v[32:35], v[40:43], 0
    v_perm_b32 v44, v114, v106, s80
    v_perm_b32 v45, v130, v122, s80
    v_perm_b32 v46, v146, v138, s80
    v_perm_b32 v47, v58, v154, s80
    s_nop 1
    v_mfma_f32_16x16x32_bf16 v[52:55], v[32:35], v[44:47], 0
    v_cndmask_b32 v36, 0, v16, s[66:67]
    v_cndmask_b32 v37, 0, v17, s[66:67]
    v_cndmask_b32 v38, 0, v18, s[66:67]
    v_cndmask_b32 v39, 0, v19, s[66:67]
    v_perm_b32 v8, v112, v104, s81
    v_perm_b32 v9, v128, v120, s81
    v_perm_b32 v10, v144, v136, s81
    v_perm_b32 v11, v56, v152, s81
    s_nop 1
    v_mfma_f32_16x16x32_bf16 v[48:51], v[36:39], v[8:11], v[48:51]
    v_perm_b32 v12, v114, v106, s81
    v_perm_b32 v13, v130, v122, s81
    v_perm_b32 v14, v146, v138, s81
    v_perm_b32 v15, v58, v154, s81
    s_nop 1
    v_mfma_f32_16x16x32_bf16 v[52:55], v[36:39], v[12:15], v[52:55]
    s_waitcnt vmcnt(2)
    s_bitcmp0_b32 s62, 2
    s_cbranch_scc1 L_b82
    s_waitcnt vmcnt(1)
L_b82:
    s_waitcnt vmcnt(2)
    s_xor_b32 s36, s35, 131584
    buffer_load_dwordx4 v[72:75], v2, s[44:47], s36 offen offset:0 nt
    v_mov_b32 v160, 82
    ds_write_b32 v163, v160
    ds_read_b32 v161, v162
    v_cndmask_b32 v32, 0, v16, s[68:69]
    v_cndmask_b32 v33, 0, v17, s[68:69]
    v_cndmask_b32 v34, 0, v18, s[68:69]
    v_cndmask_b32 v35, 0, v19, s[68:69]
    v_perm_b32 v40, v113, v105, s80
    v_perm_b32 v41, v129, v121, s80
    v_perm_b32 v42, v145, v137, s80
    v_perm_b32 v43, v57, v153, s80
    s_nop 1
    v_mfma_f32_16x16x32_bf16 v[48:51], v[32:35], v[40:43], v[48:51]
    v_perm_b32 v44, v115, v107, s80
    v_perm_b32 v45, v131, v123, s80
    v_perm_b32 v46, v147, v139, s80
    v_perm_b32 v47, v59, v155, s80
    s_nop 1
    v_mfma_f32_16x16x32_bf16 v[52:55], v[32:35], v[44:47], v[52:55]
    v_cndmask_b32 v36, 0, v16, s[70:71]
    v_cndmask_b32 v37, 0, v17, s[70:71]
    v_cndmask_b32 v38, 0, v18, s[70:71]
    v_cndmask_b32 v39, 0, v19, s[70:71]
    v_perm_b32 v8, v113, v105, s81
    v_perm_b32 v9, v129, v121, s81
    v_perm_b32 v10, v145, v137, s81
    v_perm_b32 v11, v57, v153, s81
    s_nop 1
    v_mfma_f32_16x16x32_bf16 v[48:51], v[36:39], v[8:11], v[48:51]
    v_perm_b32 v12, v115, v107, s81
    v_perm_b32 v13, v131, v123, s81
    v_perm_b32 v14, v147, v139, s81
    v_perm_b32 v15, v59, v155, s81
    s_nop 1
    v_mfma_f32_16x16x32_bf16 v[52:55], v[36:39], v[12:15], v[52:55]
    s_waitcnt lgkmcnt(0)
    v_cmp_gt_u32 vcc, 80, v161
    v_readlane_b32 s62, v161, 8
    s_and_b32 s37, vcc_lo, 0xff
    s_cselect_b32 s37, 5, 0
    s_or_b32 s62, s62, s37
    s_waitcnt vmcnt(2)
    buffer_load_dwordx4 v[76:79], v2, s[44:47], s36 offen offset:256 nt
    v_mov_b32 v160, 83
    ds_write_b32 v163, v160
    v_cndmask_b32 v32, 0, v16, s[72:73]
    v_cndmask_b32 v33, 0, v17, s[72:73]
    v_cndmask_b32 v34, 0, v18, s[72:73]
    v_cndmask_b32 v35, 0, v19, s[72:73]
    v_perm_b32 v40, v116, v108, s80
    v_perm_b32 v41, v132, v124, s80
    v_perm_b32 v42, v148, v140, s80
    v_perm_b32 v43, v60, v156, s80
    s_nop 1
    v_mfma_f32_16x16x32_bf16 v[48:51], v[32:35], v[40:43], v[48:51]
    v_perm_b32 v44, v118, v110, s80
    v_perm_b32 v45, v134, v126, s80
    v_perm_b32 v46, v150, v142, s80
    v_perm_b32 v47, v62, v158, s80
    s_nop 1
    v_mfma_f32_16x16x32_bf16 v[52:55], v[32:35], v[44:47], v[52:55]
    v_cndmask_b32 v36, 0, v16, s[74:75]
    v_cndmask_b32 v37, 0, v17, s[74:75]
    v_cndmask_b32 v38, 0, v18, s[74:75]
    v_cndmask_b32 v39, 0, v19, s[74:75]
    v_perm_b32 v8, v116, v108, s81
    v_perm_b32 v9, v132, v124, s81
    v_perm_b32 v10, v148, v140, s81
    v_perm_b32 v11, v60, v156, s81
    s_nop 1
    v_mfma_f32_16x16x32_bf16 v[48:51], v[36:39], v[8:11], v[48:51]
    v_perm_b32 v12, v118, v110, s81
    v_perm_b32 v13, v134, v126, s81
    v_perm_b32 v14, v150, v142, s81
    v_perm_b32 v15, v62, v158, s81
    s_nop 1
    v_mfma_f32_16x16x32_bf16 v[52:55], v[36:39], v[12:15], v[52:55]
    s_waitcnt vmcnt(2)
    s_bitcmp0_b32 s62, 0
    s_cbranch_scc1 L_b84
    s_waitcnt vmcnt(1)
L_b84:
    s_waitcnt vmcnt(2)
    s_xor_b32 s36, s35, 132096
    buffer_load_dwordx4 v[80:83], v2, s[44:47], s36 offen offset:0 nt
    v_mov_b32 v160, 84
    ds_write_b32 v163, v160
    ds_read_b32 v161, v162
    v_cndmask_b32 v32, 0, v16, s[76:77]
    v_cndmask_b32 v33, 0, v17, s[76:77]
    v_cndmask_b32 v34, 0, v18, s[76:77]
    v_cndmask_b32 v35, 0, v19, s[76:77]
    v_perm_b32 v40, v117, v109, s80
    v_perm_b32 v41, v133, v125, s80
    v_perm_b32 v42, v149, v141, s80
    v_perm_b32 v43, v61, v157, s80
    s_nop 1
    v_mfma_f32_16x16x32_bf16 v[48:51], v[32:35], v[40:43], v[48:51]
    v_perm_b32 v44, v119, v111, s80
    v_perm_b32 v45, v135, v127, s80
    v_perm_b32 v46, v151, v143, s80
    v_perm_b32 v47, v63, v159, s80
    s_nop 1
    v_mfma_f32_16x16x32_bf16 v[52:55], v[32:35], v[44:47], v[52:55]
    v_cndmask_b32 v36, 0, v16, s[78:79]
    v_cndmask_b32 v37, 0, v17, s[78:79]
    v_cndmask_b32 v38, 0, v18, s[78:79]
    v_cndmask_b32 v39, 0, v19, s[78:79]
    v_perm_b32 v8, v117, v109, s81
    v_perm_b32 v9, v133, v125, s81
    v_perm_b32 v10, v149, v141, s81
    v_perm_b32 v11, v61, v157, s81
    s_nop 1
    v_mfma_f32_16x16x32_bf16 v[48:51], v[36:39], v[8:11], v[48:51]
    v_perm_b32 v12, v119, v111, s81
    v_perm_b32 v13, v135, v127, s81
    v_perm_b32 v14, v151, v143, s81
    v_perm_b32 v15, v63, v159, s81
    s_nop 1
    v_mfma_f32_16x16x32_bf16 v[52:55], v[36:39], v[12:15], v[52:55]
    s_waitcnt lgkmcnt(0)
    v_cmp_gt_u32 vcc, 82, v161
    v_readlane_b32 s62, v161, 8
    s_and_b32 s37, vcc_lo, 0xff
    s_cselect_b32 s37, 5, 0
    s_or_b32 s62, s62, s37
    s_waitcnt vmcnt(2)
    buffer_load_dwordx4 v[84:87], v2, s[44:47], s36 offen offset:256 nt
    v_mov_b32 v160, 85
    ds_write_b32 v163, v160
    s_waitcnt vmcnt(2)
    s_bitcmp0_b32 s62, 2
    s_cbranch_scc1 L_b86
    s_waitcnt vmcnt(1)
L_b86:
    s_waitcnt vmcnt(2)
    s_xor_b32 s36, s35, 132608
    buffer_load_dwordx4 v[88:91], v2, s[44:47], s36 offen offset:0 nt
    v_mov_b32 v160, 86
    ds_write_b32 v163, v160
    ds_read_b32 v161, v162
    s_waitcnt lgkmcnt(0)
    v_cmp_gt_u32 vcc, 84, v161
    v_readlane_b32 s62, v161, 8
    s_and_b32 s37, vcc_lo, 0xff
    s_cselect_b32 s37, 5, 0
    s_or_b32 s62, s62, s37
    s_waitcnt vmcnt(2)
    buffer_load_dwordx4 v[92:95], v2, s[44:47], s36 offen offset:256 nt
    v_mov_b32 v160, 87
    ds_write_b32 v163, v160
    s_waitcnt vmcnt(2)
    s_bitcmp0_b32 s62, 0
    s_cbranch_scc1 L_b88
    s_waitcnt vmcnt(1)
L_b88:
    s_waitcnt vmcnt(2)
    s_xor_b32 s36, s35, 135168
    buffer_load_dwordx4 v[96:99], v2, s[44:47], s36 offen offset:0 nt
    v_mov_b32 v160, 88
    ds_write_b32 v163, v160
    ds_read_b32 v161, v162
    s_waitcnt lgkmcnt(0)
    v_cmp_gt_u32 vcc, 86, v161
    v_readlane_b32 s62, v161, 8
    s_and_b32 s37, vcc_lo, 0xff
    s_cselect_b32 s37, 5, 0
    s_or_b32 s62, s62, s37
    s_waitcnt vmcnt(2)
    buffer_load_dwordx4 v[100:103], v2, s[44:47], s36 offen offset:256 nt
    v_mov_b32 v160, 89
    ds_write_b32 v163, v160
    s_waitcnt vmcnt(2)
    s_bitcmp0_b32 s62, 2
    s_cbranch_scc1 L_b90
    s_waitcnt vmcnt(1)
L_b90:
    s_waitcnt vmcnt(2)
    s_xor_b32 s36, s35, 135680
    buffer_load_dwordx4 v[104:107], v2, s[44:47], s36 offen offset:0 nt
    v_mov_b32 v160, 90
    ds_write_b32 v163, v160
    ds_read_b32 v161, v162
    s_waitcnt lgkmcnt(0)
    v_cmp_gt_u32 vcc, 88, v161
    v_readlane_b32 s62, v161, 8
    s_and_b32 s37, vcc_lo, 0xff
    s_cselect_b32 s37, 5, 0
    s_or_b32 s62, s62, s37
    s_waitcnt vmcnt(2)
    buffer_load_dwordx4 v[108:111], v2, s[44:47], s36 offen offset:256 nt
    v_mov_b32 v160, 91
    ds_write_b32 v163, v160
    s_waitcnt vmcnt(2)
    s_bitcmp0_b32 s62, 0
    s_cbranch_scc1 L_b92
    s_waitcnt vmcnt(1)
L_b92:
    s_waitcnt vmcnt(2)
    s_xor_b32 s36, s35, 136192
    buffer_load_dwordx4 v[112:115], v2, s[44:47], s36 offen offset:0 nt
    v_mov_b32 v160, 92
    ds_write_b32 v163, v160
    ds_read_b32 v161, v162
    s_waitcnt lgkmcnt(0)
    v_cmp_gt_u32 vcc, 90, v161
    v_readlane_b32 s62, v161, 8
    s_and_b32 s37, vcc_lo, 0xff
    s_cselect_b32 s37, 5, 0
    s_or_b32 s62, s62, s37
    s_waitcnt vmcnt(2)
    buffer_load_dwordx4 v[116:119], v2, s[44:47], s36 offen offset:256 nt
    v_mov_b32 v160, 93
    ds_write_b32 v163, v160
    s_waitcnt vmcnt(2)
    s_bitcmp0_b32 s62, 2
    s_cbranch_scc1 L_b94
    s_waitcnt vmcnt(1)
L_b94:
    s_waitcnt vmcnt(2)
    s_xor_b32 s36, s35, 136704
    buffer_load_dwordx4 v[120:123], v2, s[44:47], s36 offen offset:0 nt
    v_mov_b32 v160, 94
    ds_write_b32 v163, v160
    ds_read_b32 v161, v162
    s_waitcnt lgkmcnt(0)
    v_cmp_gt_u32 vcc, 92, v161
    v_readlane_b32 s62, v161, 8
    s_and_b32 s37, vcc_lo, 0xff
    s_cselect_b32 s37, 5, 0
    s_or_b32 s62, s62, s37
    s_waitcnt vmcnt(2)
    buffer_load_dwordx4 v[124:127], v2, s[44:47], s36 offen offset:256 nt
    v_mov_b32 v160, 95
    ds_write_b32 v163, v160
    s_waitcnt vmcnt(2)
    s_bitcmp0_b32 s62, 0
    s_cbranch_scc1 L_b96
    s_waitcnt vmcnt(1)
L_b96:
    s_waitcnt vmcnt(2)
    s_xor_b32 s36, s35, 262144
    buffer_load_dwordx4 v[128:131], v2, s[44:47], s36 offen offset:0 nt
    v_mov_b32 v160, 96
    ds_write_b32 v163, v160
    ds_read_b32 v161, v162
    s_waitcnt lgkmcnt(0)
    v_cmp_gt_u32 vcc, 94, v161
    v_readlane_b32 s62, v161, 8
    s_and_b32 s37, vcc_lo, 0xff
    s_cselect_b32 s37, 5, 0
    s_or_b32 s62, s62, s37
    s_waitcnt vmcnt(2)
    buffer_load_dwordx4 v[132:135], v2, s[44:47], s36 offen offset:256 nt
    v_mov_b32 v160, 97
    ds_write_b32 v163, v160
    v_cndmask_b32 v32, 0, v20, s[64:65]
    v_cndmask_b32 v33, 0, v21, s[64:65]
    v_cndmask_b32 v34, 0, v22, s[64:65]
    v_cndmask_b32 v35, 0, v23, s[64:65]
    v_perm_b32 v40, v72, v64, s80
    v_perm_b32 v41, v88, v80, s80
    v_perm_b32 v42, v104, v96, s80
    v_perm_b32 v43, v120, v112, s80
    s_nop 1
    v_mfma_f32_16x16x32_bf16 v[48:51], v[32:35], v[40:43], v[48:51]
    v_perm_b32 v44, v74, v66, s80
    v_perm_b32 v45, v90, v82, s80
    v_perm_b32 v46, v106, v98, s80
    v_perm_b32 v47, v122, v114, s80
    s_nop 1
    v_mfma_f32_16x16x32_bf16 v[52:55], v[32:35], v[44:47], v[52:55]
    v_cndmask_b32 v36, 0, v20, s[66:67]
    v_cndmask_b32 v37, 0, v21, s[66:67]
    v_cndmask_b32 v38, 0, v22, s[66:67]
    v_cndmask_b32 v39, 0, v23, s[66:67]
    v_perm_b32 v8, v72, v64, s81
    v_perm_b32 v9, v88, v80, s81
    v_perm_b32 v10, v104, v96, s81
    v_perm_b32 v11, v120, v112, s81
    s_nop 1
    v_mfma_f32_16x16x32_bf16 v[48:51], v[36:39], v[8:11], v[48:51]
    v_perm_b32 v12, v74, v66, s81
    v_perm_b32 v13, v90, v82, s81
    v_perm_b32 v14, v106, v98, s81
    v_perm_b32 v15, v122, v114, s81
    s_nop 1
    v_mfma_f32_16x16x32_bf16 v[52:55], v[36:39], v[12:15], v[52:55]
    s_waitcnt vmcnt(2)
    s_bitcmp0_b32 s62, 2
    s_cbranch_scc1 L_b98
    s_waitcnt vmcnt(1)
L_b98:
    s_waitcnt vmcnt(2)
    s_xor_b32 s36, s35, 262656
    buffer_load_dwordx4 v[136:139], v2, s[44:47], s36 offen offset:0 nt
    v_mov_b32 v160, 98
    ds_write_b32 v163, v160
    ds_read_b32 v161, v162
    v_cndmask_b32 v32, 0, v20, s[68:69]
    v_cndmask_b32 v33, 0, v21, s[68:69]
    v_cndmask_b32 v34, 0, v22, s[68:69]
    v_cndmask_b32 v35, 0, v23, s[68:69]
    v_perm_b32 v40, v73, v65, s80
    v_perm_b32 v41, v89, v81, s80
    v_perm_b32 v42, v105, v97, s80
    v_perm_b32 v43, v121, v113, s80
    s_nop 1
    v_mfma_f32_16x16x32_bf16 v[48:51], v[32:35], v[40:43], v[48:51]
    v_perm_b32 v44, v75, v67, s80
    v_perm_b32 v45, v91, v83, s80
    v_perm_b32 v46, v107, v99, s80
    v_perm_b32 v47, v123, v115, s80
    s_nop 1
    v_mfma_f32_16x16x32_bf16 v[52:55], v[32:35], v[44:47], v[52:55]
    v_cndmask_b32 v36, 0, v20, s[70:71]
    v_cndmask_b32 v37, 0, v21, s[70:71]
    v_cndmask_b32 v38, 0, v22, s[70:71]
    v_cndmask_b32 v39, 0, v23, s[70:71]
    v_perm_b32 v8, v73, v65, s81
    v_perm_b32 v9, v89, v81, s81
    v_perm_b32 v10, v105, v97, s81
    v_perm_b32 v11, v121, v113, s81
    s_nop 1
    v_mfma_f32_16x16x32_bf16 v[48:51], v[36:39], v[8:11], v[48:51]
    v_perm_b32 v12, v75, v67, s81
    v_perm_b32 v13, v91, v83, s81
    v_perm_b32 v14, v107, v99, s81
    v_perm_b32 v15, v123, v115, s81
    s_nop 1
    v_mfma_f32_16x16x32_bf16 v[52:55], v[36:39], v[12:15], v[52:55]
    s_waitcnt lgkmcnt(0)
    v_cmp_gt_u32 vcc, 96, v161
    v_readlane_b32 s62, v161, 8
    s_and_b32 s37, vcc_lo, 0xff
    s_cselect_b32 s37, 5, 0
    s_or_b32 s62, s62, s37
    s_waitcnt vmcnt(2)
    buffer_load_dwordx4 v[140:143], v2, s[44:47], s36 offen offset:256 nt
    v_mov_b32 v160, 99
    ds_write_b32 v163, v160
    v_cndmask_b32 v32, 0, v20, s[72:73]
    v_cndmask_b32 v33, 0, v21, s[72:73]
    v_cndmask_b32 v34, 0, v22, s[72:73]
    v_cndmask_b32 v35, 0, v23, s[72:73]
    v_perm_b32 v40, v76, v68, s80
    v_perm_b32 v41, v92, v84, s80
    v_perm_b32 v42, v108, v100, s80
    v_perm_b32 v43, v124, v116, s80
    s_nop 1
    v_mfma_f32_16x16x32_bf16 v[48:51], v[32:35], v[40:43], v[48:51]
    v_perm_b32 v44, v78, v70, s80
    v_perm_b32 v45, v94, v86, s80
    v_perm_b32 v46, v110, v102, s80
    v_perm_b32 v47, v126, v118, s80
    s_nop 1
    v_mfma_f32_16x16x32_bf16 v[52:55], v[32:35], v[44:47], v[52:55]
    v_cndmask_b32 v36, 0, v20, s[74:75]
    v_cndmask_b32 v37, 0, v21, s[74:75]
    v_cndmask_b32 v38, 0, v22, s[74:75]
    v_cndmask_b32 v39, 0, v23, s[74:75]
    v_perm_b32 v8, v76, v68, s81
    v_perm_b32 v9, v92, v84, s81
    v_perm_b32 v10, v108, v100, s81
    v_perm_b32 v11, v124, v116, s81
    s_nop 1
    v_mfma_f32_16x16x32_bf16 v[48:51], v[36:39], v[8:11], v[48:51]
    v_perm_b32 v12, v78, v70, s81
    v_perm_b32 v13, v94, v86, s81
    v_perm_b32 v14, v110, v102, s81
    v_perm_b32 v15, v126, v118, s81
    s_nop 1
    v_mfma_f32_16x16x32_bf16 v[52:55], v[36:39], v[12:15], v[52:55]
    s_waitcnt vmcnt(2)
    s_bitcmp0_b32 s62, 0
    s_cbranch_scc1 L_b100
    s_waitcnt vmcnt(1)
L_b100:
    s_waitcnt vmcnt(2)
    s_xor_b32 s36, s35, 263168
    buffer_load_dwordx4 v[144:147], v2, s[44:47], s36 offen offset:0 nt
    v_mov_b32 v160, 100
    ds_write_b32 v163, v160
    ds_read_b32 v161, v162
    v_cndmask_b32 v32, 0, v20, s[76:77]
    v_cndmask_b32 v33, 0, v21, s[76:77]
    v_cndmask_b32 v34, 0, v22, s[76:77]
    v_cndmask_b32 v35, 0, v23, s[76:77]
    v_perm_b32 v40, v77, v69, s80
    v_perm_b32 v41, v93, v85, s80
    v_perm_b32 v42, v109, v101, s80
    v_perm_b32 v43, v125, v117, s80
    s_nop 1
    v_mfma_f32_16x16x32_bf16 v[48:51], v[32:35], v[40:43], v[48:51]
    v_perm_b32 v44, v79, v71, s80
    v_perm_b32 v45, v95, v87, s80
    v_perm_b32 v46, v111, v103, s80
    v_perm_b32 v47, v127, v119, s80
    s_nop 1
    v_mfma_f32_16x16x32_bf16 v[52:55], v[32:35], v[44:47], v[52:55]
    v_cndmask_b32 v36, 0, v20, s[78:79]
    v_cndmask_b32 v37, 0, v21, s[78:79]
    v_cndmask_b32 v38, 0, v22, s[78:79]
    v_cndmask_b32 v39, 0, v23, s[78:79]
    v_perm_b32 v8, v77, v69, s81
    v_perm_b32 v9, v93, v85, s81
    v_perm_b32 v10, v109, v101, s81
    v_perm_b32 v11, v125, v117, s81
    s_nop 1
    v_mfma_f32_16x16x32_bf16 v[48:51], v[36:39], v[8:11], v[48:51]
    v_perm_b32 v12, v79, v71, s81
    v_perm_b32 v13, v95, v87, s81
    v_perm_b32 v14, v111, v103, s81
    v_perm_b32 v15, v127, v119, s81
    s_nop 1
    v_mfma_f32_16x16x32_bf16 v[52:55], v[36:39], v[12:15], v[52:55]
    s_waitcnt lgkmcnt(0)
    v_cmp_gt_u32 vcc, 98, v161
    v_readlane_b32 s62, v161, 8
    s_and_b32 s37, vcc_lo, 0xff
    s_cselect_b32 s37, 5, 0
    s_or_b32 s62, s62, s37
    s_waitcnt vmcnt(2)
    buffer_load_dwordx4 v[148:151], v2, s[44:47], s36 offen offset:256 nt
    v_mov_b32 v160, 101
    ds_write_b32 v163, v160
    s_waitcnt vmcnt(2)
    s_bitcmp0_b32 s62, 2
    s_cbranch_scc1 L_b102
    s_waitcnt vmcnt(1)
L_b102:
    s_waitcnt vmcnt(2)
    s_xor_b32 s36, s35, 263680
    buffer_load_dwordx4 v[152:155], v2, s[44:47], s36 offen offset:0 nt
    v_mov_b32 v160, 102
    ds_write_b32 v163, v160
    ds_read_b32 v161, v162
    s_waitcnt lgkmcnt(0)
    v_cmp_gt_u32 vcc, 100, v161
    v_readlane_b32 s62, v161, 8
    s_and_b32 s37, vcc_lo, 0xff
    s_cselect_b32 s37, 5, 0
    s_or_b32 s62, s62, s37
    s_waitcnt vmcnt(2)
    buffer_load_dwordx4 v[156:159], v2, s[44:47], s36 offen offset:256 nt
    v_mov_b32 v160, 103
    ds_write_b32 v163, v160
    s_waitcnt vmcnt(2)
    s_bitcmp0_b32 s62, 0
    s_cbranch_scc1 L_b104
    s_waitcnt vmcnt(1)
L_b104:
    s_waitcnt vmcnt(2)
    s_xor_b32 s36, s35, 266240
    buffer_load_dwordx4 v[56:59], v2, s[44:47], s36 offen offset:0 nt
    v_mov_b32 v160, 104
    ds_write_b32 v163, v160
    ds_read_b32 v161, v162
    s_waitcnt lgkmcnt(0)
    v_cmp_gt_u32 vcc, 102, v161
    v_readlane_b32 s62, v161, 8
    s_and_b32 s37, vcc_lo, 0xff
    s_cselect_b32 s37, 5, 0
    s_or_b32 s62, s62, s37
    s_waitcnt vmcnt(2)
    buffer_load_dwordx4 v[60:63], v2, s[44:47], s36 offen offset:256 nt
    v_mov_b32 v160, 105
    ds_write_b32 v163, v160
    s_waitcnt vmcnt(2)
    s_bitcmp0_b32 s62, 2
    s_cbranch_scc1 L_b106
    s_waitcnt vmcnt(1)
L_b106:
    s_waitcnt vmcnt(2)
    s_xor_b32 s36, s35, 266752
    buffer_load_dwordx4 v[64:67], v2, s[44:47], s36 offen offset:0 nt
    v_mov_b32 v160, 106
    ds_write_b32 v163, v160
    ds_read_b32 v161, v162
    s_waitcnt lgkmcnt(0)
    v_cmp_gt_u32 vcc, 104, v161
    v_readlane_b32 s62, v161, 8
    s_and_b32 s37, vcc_lo, 0xff
    s_cselect_b32 s37, 5, 0
    s_or_b32 s62, s62, s37
    s_waitcnt vmcnt(2)
    buffer_load_dwordx4 v[68:71], v2, s[44:47], s36 offen offset:256 nt
    v_mov_b32 v160, 107
    ds_write_b32 v163, v160
    s_waitcnt vmcnt(2)
    s_bitcmp0_b32 s62, 0
    s_cbranch_scc1 L_b108
    s_waitcnt vmcnt(1)
L_b108:
    s_waitcnt vmcnt(2)
    s_xor_b32 s36, s35, 267264
    buffer_load_dwordx4 v[72:75], v2, s[44:47], s36 offen offset:0 nt
    v_mov_b32 v160, 108
    ds_write_b32 v163, v160
    ds_read_b32 v161, v162
    s_waitcnt lgkmcnt(0)
    v_cmp_gt_u32 vcc, 106, v161
    v_readlane_b32 s62, v161, 8
    s_and_b32 s37, vcc_lo, 0xff
    s_cselect_b32 s37, 5, 0
    s_or_b32 s62, s62, s37
    s_waitcnt vmcnt(2)
    buffer_load_dwordx4 v[76:79], v2, s[44:47], s36 offen offset:256 nt
    v_mov_b32 v160, 109
    ds_write_b32 v163, v160
    s_waitcnt vmcnt(2)
    s_bitcmp0_b32 s62, 2
    s_cbranch_scc1 L_b110
    s_waitcnt vmcnt(1)
L_b110:
    s_waitcnt vmcnt(2)
    s_xor_b32 s36, s35, 267776
    buffer_load_dwordx4 v[80:83], v2, s[44:47], s36 offen offset:0 nt
    v_mov_b32 v160, 110
    ds_write_b32 v163, v160
    ds_read_b32 v161, v162
    s_waitcnt lgkmcnt(0)
    v_cmp_gt_u32 vcc, 108, v161
    v_readlane_b32 s62, v161, 8
    s_and_b32 s37, vcc_lo, 0xff
    s_cselect_b32 s37, 5, 0
    s_or_b32 s62, s62, s37
    s_waitcnt vmcnt(2)
    buffer_load_dwordx4 v[84:87], v2, s[44:47], s36 offen offset:256 nt
    v_mov_b32 v160, 111
    ds_write_b32 v163, v160
    s_waitcnt vmcnt(2)
    s_bitcmp0_b32 s62, 0
    s_cbranch_scc1 L_b112
    s_waitcnt vmcnt(1)
L_b112:
    s_waitcnt vmcnt(2)
    s_xor_b32 s36, s35, 393216
    buffer_load_dwordx4 v[88:91], v2, s[44:47], s36 offen offset:0 nt
    v_mov_b32 v160, 112
    ds_write_b32 v163, v160
    ds_read_b32 v161, v162
    s_waitcnt lgkmcnt(0)
    v_cmp_gt_u32 vcc, 110, v161
    v_readlane_b32 s62, v161, 8
    s_and_b32 s37, vcc_lo, 0xff
    s_cselect_b32 s37, 5, 0
    s_or_b32 s62, s62, s37
    s_waitcnt vmcnt(2)
    s_xor_b32 s36, s35, 393728
    buffer_load_dwordx4 v[92:95], v2, s[44:47], s36 offen offset:0 nt
    v_mov_b32 v160, 113
    ds_write_b32 v163, v160
    v_cndmask_b32 v32, 0, v24, s[64:65]
    v_cndmask_b32 v33, 0, v25, s[64:65]
    v_cndmask_b32 v34, 0, v26, s[64:65]
    v_cndmask_b32 v35, 0, v27, s[64:65]
    v_perm_b32 v40, v136, v128, s80
    v_perm_b32 v41, v152, v144, s80
    v_perm_b32 v42, v64, v56, s80
    v_perm_b32 v43, v80, v72, s80
    s_nop 1
    v_mfma_f32_16x16x32_bf16 v[48:51], v[32:35], v[40:43], v[48:51]
    v_perm_b32 v44, v138, v130, s80
    v_perm_b32 v45, v154, v146, s80
    v_perm_b32 v46, v66, v58, s80
    v_perm_b32 v47, v82, v74, s80
    s_nop 1
    v_mfma_f32_16x16x32_bf16 v[52:55], v[32:35], v[44:47], v[52:55]
    v_cndmask_b32 v36, 0, v24, s[66:67]
    v_cndmask_b32 v37, 0, v25, s[66:67]
    v_cndmask_b32 v38, 0, v26, s[66:67]
    v_cndmask_b32 v39, 0, v27, s[66:67]
    v_perm_b32 v8, v136, v128, s81
    v_perm_b32 v9, v152, v144, s81
    v_perm_b32 v10, v64, v56, s81
    v_perm_b32 v11, v80, v72, s81
    s_nop 1
    v_mfma_f32_16x16x32_bf16 v[48:51], v[36:39], v[8:11], v[48:51]
    v_perm_b32 v12, v138, v130, s81
    v_perm_b32 v13, v154, v146, s81
    v_perm_b32 v14, v66, v58, s81
    v_perm_b32 v15, v82, v74, s81
    s_nop 1
    v_mfma_f32_16x16x32_bf16 v[52:55], v[36:39], v[12:15], v[52:55]
    s_waitcnt vmcnt(2)
    s_bitcmp0_b32 s62, 2
    s_cbranch_scc1 L_b114
    s_waitcnt vmcnt(1)
L_b114:
    s_waitcnt vmcnt(2)
    s_xor_b32 s36, s35, 394240
    buffer_load_dwordx4 v[96:99], v2, s[44:47], s36 offen offset:0 nt
    v_mov_b32 v160, 114
    ds_write_b32 v163, v160
    ds_read_b32 v161, v162
    v_cndmask_b32 v32, 0, v24, s[68:69]
    v_cndmask_b32 v33, 0, v25, s[68:69]
    v_cndmask_b32 v34, 0, v26, s[68:69]
    v_cndmask_b32 v35, 0, v27, s[68:69]
    v_perm_b32 v40, v137, v129, s80
    v_perm_b32 v41, v153, v145, s80
    v_perm_b32 v42, v65, v57, s80
    v_perm_b32 v43, v81, v73, s80
    s_nop 1
    v_mfma_f32_16x16x32_bf16 v[48:51], v[32:35], v[40:43], v[48:51]
    v_perm_b32 v44, v139, v131, s80
    v_perm_b32 v45, v155, v147, s80
    v_perm_b32 v46, v67, v59, s80
    v_perm_b32 v47, v83, v75, s80
    s_nop 1
    v_mfma_f32_16x16x32_bf16 v[52:55], v[32:35], v[44:47], v[52:55]
    v_cndmask_b32 v36, 0, v24, s[70:71]
    v_cndmask_b32 v37, 0, v25, s[70:71]
    v_cndmask_b32 v38, 0, v26, s[70:71]
    v_cndmask_b32 v39, 0, v27, s[70:71]
    v_perm_b32 v8, v137, v129, s81
    v_perm_b32 v9, v153, v145, s81
    v_perm_b32 v10, v65, v57, s81
    v_perm_b32 v11, v81, v73, s81
    s_nop 1
    v_mfma_f32_16x16x32_bf16 v[48:51], v[36:39], v[8:11], v[48:51]
    v_perm_b32 v12, v139, v131, s81
    v_perm_b32 v13, v155, v147, s81
    v_perm_b32 v14, v67, v59, s81
    v_perm_b32 v15, v83, v75, s81
    s_nop 1
    v_mfma_f32_16x16x32_bf16 v[52:55], v[36:39], v[12:15], v[52:55]
    s_waitcnt lgkmcnt(0)
    v_cmp_gt_u32 vcc, 112, v161
    v_readlane_b32 s62, v161, 8
    s_and_b32 s37, vcc_lo, 0xff
    s_cselect_b32 s37, 5, 0
    s_or_b32 s62, s62, s37
    s_waitcnt vmcnt(2)
    s_xor_b32 s36, s35, 394752
    buffer_load_dwordx4 v[100:103], v2, s[44:47], s36 offen offset:0 nt
    v_mov_b32 v160, 115
    ds_write_b32 v163, v160
    v_cndmask_b32 v32, 0, v24, s[72:73]
    v_cndmask_b32 v33, 0, v25, s[72:73]
    v_cndmask_b32 v34, 0, v26, s[72:73]
    v_cndmask_b32 v35, 0, v27, s[72:73]
    v_perm_b32 v40, v140, v132, s80
    v_perm_b32 v41, v156, v148, s80
    v_perm_b32 v42, v68, v60, s80
    v_perm_b32 v43, v84, v76, s80
    s_nop 1
    v_mfma_f32_16x16x32_bf16 v[48:51], v[32:35], v[40:43], v[48:51]
    v_perm_b32 v44, v142, v134, s80
    v_perm_b32 v45, v158, v150, s80
    v_perm_b32 v46, v70, v62, s80
    v_perm_b32 v47, v86, v78, s80
    s_nop 1
    v_mfma_f32_16x16x32_bf16 v[52:55], v[32:35], v[44:47], v[52:55]
    v_cndmask_b32 v36, 0, v24, s[74:75]
    v_cndmask_b32 v37, 0, v25, s[74:75]
    v_cndmask_b32 v38, 0, v26, s[74:75]
    v_cndmask_b32 v39, 0, v27, s[74:75]
    v_perm_b32 v8, v140, v132, s81
    v_perm_b32 v9, v156, v148, s81
    v_perm_b32 v10, v68, v60, s81
    v_perm_b32 v11, v84, v76, s81
    s_nop 1
    v_mfma_f32_16x16x32_bf16 v[48:51], v[36:39], v[8:11], v[48:51]
    v_perm_b32 v12, v142, v134, s81
    v_perm_b32 v13, v158, v150, s81
    v_perm_b32 v14, v70, v62, s81
    v_perm_b32 v15, v86, v78, s81
    s_nop 1
    v_mfma_f32_16x16x32_bf16 v[52:55], v[36:39], v[12:15], v[52:55]
    s_waitcnt vmcnt(2)
    s_bitcmp0_b32 s62, 0
    s_cbranch_scc1 L_b116
    s_waitcnt vmcnt(1)
L_b116:
    s_waitcnt vmcnt(2)
    s_xor_b32 s36, s35, 397312
    buffer_load_dwordx4 v[104:107], v2, s[44:47], s36 offen offset:0 nt
    v_mov_b32 v160, 116
    ds_write_b32 v163, v160
    ds_read_b32 v161, v162
    v_cndmask_b32 v32, 0, v24, s[76:77]
    v_cndmask_b32 v33, 0, v25, s[76:77]
    v_cndmask_b32 v34, 0, v26, s[76:77]
    v_cndmask_b32 v35, 0, v27, s[76:77]
    v_perm_b32 v40, v141, v133, s80
    v_perm_b32 v41, v157, v149, s80
    v_perm_b32 v42, v69, v61, s80
    v_perm_b32 v43, v85, v77, s80
    s_nop 1
    v_mfma_f32_16x16x32_bf16 v[48:51], v[32:35], v[40:43], v[48:51]
    v_perm_b32 v44, v143, v135, s80
    v_perm_b32 v45, v159, v151, s80
    v_perm_b32 v46, v71, v63, s80
    v_perm_b32 v47, v87, v79, s80
    s_nop 1
    v_mfma_f32_16x16x32_bf16 v[52:55], v[32:35], v[44:47], v[52:55]
    v_cndmask_b32 v36, 0, v24, s[78:79]
    v_cndmask_b32 v37, 0, v25, s[78:79]
    v_cndmask_b32 v38, 0, v26, s[78:79]
    v_cndmask_b32 v39, 0, v27, s[78:79]
    v_perm_b32 v8, v141, v133, s81
    v_perm_b32 v9, v157, v149, s81
    v_perm_b32 v10, v69, v61, s81
    v_perm_b32 v11, v85, v77, s81
    s_nop 1
    v_mfma_f32_16x16x32_bf16 v[48:51], v[36:39], v[8:11], v[48:51]
    v_perm_b32 v12, v143, v135, s81
    v_perm_b32 v13, v159, v151, s81
    v_perm_b32 v14, v71, v63, s81
    v_perm_b32 v15, v87, v79, s81
    s_nop 1
    v_mfma_f32_16x16x32_bf16 v[52:55], v[36:39], v[12:15], v[52:55]
    s_waitcnt lgkmcnt(0)
    v_cmp_gt_u32 vcc, 114, v161
    v_readlane_b32 s62, v161, 8
    s_and_b32 s37, vcc_lo, 0xff
    s_cselect_b32 s37, 5, 0
    s_or_b32 s62, s62, s37
    s_waitcnt vmcnt(2)
    s_xor_b32 s36, s35, 397824
    buffer_load_dwordx4 v[108:111], v2, s[44:47], s36 offen offset:0 nt
    v_mov_b32 v160, 117
    ds_write_b32 v163, v160
    s_waitcnt vmcnt(2)
    s_bitcmp0_b32 s62, 2
    s_cbranch_scc1 L_b118
    s_waitcnt vmcnt(1)
L_b118:
    s_waitcnt vmcnt(2)
    s_xor_b32 s36, s35, 398336
    buffer_load_dwordx4 v[112:115], v2, s[44:47], s36 offen offset:0 nt
    v_mov_b32 v160, 118
    ds_write_b32 v163, v160
    ds_read_b32 v161, v162
    s_waitcnt lgkmcnt(0)
    v_cmp_gt_u32 vcc, 116, v161
    v_readlane_b32 s62, v161, 8
    s_and_b32 s37, vcc_lo, 0xff
    s_cselect_b32 s37, 5, 0
    s_or_b32 s62, s62, s37
    s_waitcnt vmcnt(2)
    s_xor_b32 s36, s35, 398848
    buffer_load_dwordx4 v[116:119], v2, s[44:47], s36 offen offset:0 nt
    v_mov_b32 v160, 119
    ds_write_b32 v163, v160
    s_xor_b32 s36, s35, 393216
    buffer_load_dwordx4 v[120:123], v2, s[44:47], s36 offen offset:256 nt
    v_mov_b32 v160, 120
    ds_write_b32 v163, v160
    ds_read_b32 v161, v162
    s_waitcnt lgkmcnt(0)
    v_cmp_gt_u32 vcc, 118, v161
    v_readlane_b32 s62, v161, 8
    s_and_b32 s37, vcc_lo, 0xff
    s_cselect_b32 s37, 5, 0
    s_or_b32 s62, s62, s37
    s_waitcnt vmcnt(3)
    s_xor_b32 s36, s35, 393728
    buffer_load_dwordx4 v[124:127], v2, s[44:47], s36 offen offset:256 nt
    s_waitcnt vmcnt(3)
    s_xor_b32 s36, s35, 394240
    buffer_load_dwordx4 v[128:131], v2, s[44:47], s36 offen offset:256 nt
    s_waitcnt vmcnt(3)
    s_xor_b32 s36, s35, 394752
    buffer_load_dwordx4 v[132:135], v2, s[44:47], s36 offen offset:256 nt
    v_cndmask_b32 v32, 0, v28, s[64:65]
    v_cndmask_b32 v33, 0, v29, s[64:65]
    v_cndmask_b32 v34, 0, v30, s[64:65]
    v_cndmask_b32 v35, 0, v31, s[64:65]
    v_perm_b32 v40, v92, v88, s80
    v_perm_b32 v41, v100, v96, s80
    v_perm_b32 v42, v108, v104, s80
    v_perm_b32 v43, v116, v112, s80
    s_nop 1
    v_mfma_f32_16x16x32_bf16 v[48:51], v[32:35], v[40:43], v[48:51]
    v_perm_b32 v44, v94, v90, s80
    v_perm_b32 v45, v102, v98, s80
    v_perm_b32 v46, v110, v106, s80
    v_perm_b32 v47, v118, v114, s80
    s_nop 1
    v_mfma_f32_16x16x32_bf16 v[52:55], v[32:35], v[44:47], v[52:55]
    v_cndmask_b32 v36, 0, v28, s[66:67]
    v_cndmask_b32 v37, 0, v29, s[66:67]
    v_cndmask_b32 v38, 0, v30, s[66:67]
    v_cndmask_b32 v39, 0, v31, s[66:67]
    v_perm_b32 v8, v92, v88, s81
    v_perm_b32 v9, v100, v96, s81
    v_perm_b32 v10, v108, v104, s81
    v_perm_b32 v11, v116, v112, s81
    s_nop 1
    v_mfma_f32_16x16x32_bf16 v[48:51], v[36:39], v[8:11], v[48:51]
    v_perm_b32 v12, v94, v90, s81
    v_perm_b32 v13, v102, v98, s81
    v_perm_b32 v14, v110, v106, s81
    v_perm_b32 v15, v118, v114, s81
    s_nop 1
    v_mfma_f32_16x16x32_bf16 v[52:55], v[36:39], v[12:15], v[52:55]
    s_waitcnt vmcnt(3)
    s_xor_b32 s36, s35, 397312
    buffer_load_dwordx4 v[136:139], v2, s[44:47], s36 offen offset:256 nt
    v_cndmask_b32 v32, 0, v28, s[68:69]
    v_cndmask_b32 v33, 0, v29, s[68:69]
    v_cndmask_b32 v34, 0, v30, s[68:69]
    v_cndmask_b32 v35, 0, v31, s[68:69]
    v_perm_b32 v40, v93, v89, s80
    v_perm_b32 v41, v101, v97, s80
    v_perm_b32 v42, v109, v105, s80
    v_perm_b32 v43, v117, v113, s80
    s_nop 1
    v_mfma_f32_16x16x32_bf16 v[48:51], v[32:35], v[40:43], v[48:51]
    v_perm_b32 v44, v95, v91, s80
    v_perm_b32 v45, v103, v99, s80
    v_perm_b32 v46, v111, v107, s80
    v_perm_b32 v47, v119, v115, s80
    s_nop 1
    v_mfma_f32_16x16x32_bf16 v[52:55], v[32:35], v[44:47], v[52:55]
    v_cndmask_b32 v36, 0, v28, s[70:71]
    v_cndmask_b32 v37, 0, v29, s[70:71]
    v_cndmask_b32 v38, 0, v30, s[70:71]
    v_cndmask_b32 v39, 0, v31, s[70:71]
    v_perm_b32 v8, v93, v89, s81
    v_perm_b32 v9, v101, v97, s81
    v_perm_b32 v10, v109, v105, s81
    v_perm_b32 v11, v117, v113, s81
    s_nop 1
    v_mfma_f32_16x16x32_bf16 v[48:51], v[36:39], v[8:11], v[48:51]
    v_perm_b32 v12, v95, v91, s81
    v_perm_b32 v13, v103, v99, s81
    v_perm_b32 v14, v111, v107, s81
    v_perm_b32 v15, v119, v115, s81
    s_nop 1
    v_mfma_f32_16x16x32_bf16 v[52:55], v[36:39], v[12:15], v[52:55]
    s_waitcnt vmcnt(3)
    s_xor_b32 s36, s35, 397824
    buffer_load_dwordx4 v[140:143], v2, s[44:47], s36 offen offset:256 nt
    v_cndmask_b32 v32, 0, v28, s[72:73]
    v_cndmask_b32 v33, 0, v29, s[72:73]
    v_cndmask_b32 v34, 0, v30, s[72:73]
    v_cndmask_b32 v35, 0, v31, s[72:73]
    v_cndmask_b32 v36, 0, v28, s[74:75]
    v_cndmask_b32 v37, 0, v29, s[74:75]
    v_cndmask_b32 v38, 0, v30, s[74:75]
    v_cndmask_b32 v39, 0, v31, s[74:75]
    v_cndmask_b32 v40, 0, v28, s[76:77]
    v_cndmask_b32 v41, 0, v29, s[76:77]
    v_cndmask_b32 v42, 0, v30, s[76:77]
    v_cndmask_b32 v43, 0, v31, s[76:77]
    v_cndmask_b32 v44, 0, v28, s[78:79]
    v_cndmask_b32 v45, 0, v29, s[78:79]
    v_cndmask_b32 v46, 0, v30, s[78:79]
    v_cndmask_b32 v47, 0, v31, s[78:79]
    v_perm_b32 v88, v124, v120, s80
    v_perm_b32 v104, v126, v122, s80
    v_perm_b32 v92, v124, v120, s81
    v_perm_b32 v108, v126, v122, s81
    v_perm_b32 v96, v125, v121, s80
    v_perm_b32 v112, v127, v123, s80
    v_perm_b32 v100, v125, v121, s81
    v_perm_b32 v116, v127, v123, s81
    s_waitcnt vmcnt(3)
    s_xor_b32 s36, s35, 398336
    buffer_load_dwordx4 v[144:147], v2, s[44:47], s36 offen offset:256 nt
    s_waitcnt vmcnt(3)
    s_xor_b32 s36, s35, 398848
    buffer_load_dwordx4 v[148:151], v2, s[44:47], s36 offen offset:256 nt
    v_perm_b32 v89, v132, v128, s80
    v_perm_b32 v105, v134, v130, s80
    v_perm_b32 v93, v132, v128, s81
    v_perm_b32 v109, v134, v130, s81
    v_perm_b32 v97, v133, v129, s80
    v_perm_b32 v113, v135, v131, s80
    v_perm_b32 v101, v133, v129, s81
    v_perm_b32 v117, v135, v131, s81
    v_lshrrev_b32 v3, 3, v0
    v_mul_u32_u24 v4, 896, v3
    v_and_b32 v3, 6, v3
    v_xor_b32 v3, v3, v0
    v_and_b32 v3, 7, v3
    v_lshl_add_u32 v4, v3, 4, v4
    v_mov_b32 v163, v4
    s_and_b32 s36, s32, 3
    s_lshl_b32 s37, s31, 2
    s_add_u32 s36, s36, s37
    s_lshr_b32 s39, s32, 2
    s_lshl_b32 s39, s39, 7
    s_mul_i32 s37, s36, 114688
    s_add_u32 s37, s37, s39
    s_cmp_lt_u32 s32, 28
    s_cselect_b32 s37, s37, 0
    s_cselect_b32 s62, 113920, 0
    s_add_u32 s56, s12, s37
    s_addc_u32 s57, s13, 0
    s_mov_b32 s58, s62
    s_mov_b32 s59, 0x20000
    s_mul_i32 s37, s36, 50176
    s_add_u32 s37, s37, s39
    s_cmp_lt_u32 s32, 28
    s_cselect_b32 s37, s37, 0
    s_cselect_b32 s62, 49408, 0
    s_add_u32 s48, s20, s37
    s_addc_u32 s49, s21, 0
    s_mov_b32 s50, s62
    s_mov_b32 s51, 0x20000
    s_mul_i32 s64, s30, 14336
    s_add_u32 s65, s64, 7168
    s_lshr_b32 s66, s64, 1
    s_lshl_b32 s67, s30, 11
    s_add_u32 s67, s67, 32768
    s_lshl_b32 s68, s30, 10
    s_add_u32 s68, s68, 49152
    v_lshrrev_b32 v3, 5, v0
    v_lshlrev_b32 v3, 9, v3
    v_bfe_u32 v4, v0, 4, 1
    v_lshl_add_u32 v3, v4, 10, v3
    v_and_b32 v4, 15, v0
    v_lshl_add_u32 v3, v4, 5, v3
    s_lshl_b32 s37, s30, 11
    s_add_u32 s37, s37, 57344
    v_add_u32 v3, s37, v3
    s_lshl_b32 s37, s30, 8
    s_add_u32 s37, s37, 57344
    v_lshl_add_u32 v4, v0, 2, s37
    s_lshr_b32 s37, s30, 2
    s_lshl_b32 s37, s37, 5
    s_add_u32 s37, s37, 82176
    v_mov_b32 v5, s37
    v_lshlrev_b32 v6, 2, v0
    s_lshl_b32 s60, s38, 12
    s_lshl_b32 s37, s30, 8
    s_add_u32 s60, s60, s37
    s_add_u32 s60, s60, 851968
    s_xor_b32 s85, s85, 0x55
    v_lshrrev_b32 v1, 4, v0
    v_bfe_u32 v7, v0, 2, 2
    v_and_b32 v8, 3, v0
    v_lshl_add_u32 v7, v1, 2, v7
    v_bfe_u32 v2, v7, 1, 2
    v_xor_b32 v2, s30, v2
    v_and_b32 v2, 3, v2
    v_lshlrev_b32 v7, 7, v7
    v_lshl_add_u32 v7, v8, 3, v7
    v_lshl_add_u32 v7, v2, 5, v7
    v_add_u32 v7, 32768, v7
    v_and_b32 v2, 15, v0
    v_lshlrev_b32 v2, 4, v2
    v_lshl_add_u32 v2, v1, 12, v2
    s_lshl_b32 s61, s30, 17
    s_lshl_b32 s37, s31, 14
    s_add_u32 s61, s61, s37
    s_and_b32 s37, s32, 3
    s_lshl_b32 s37, s37, 9
    s_add_u32 s61, s61, s37
    s_add_u32 s61, s61, 851968
    v_lshl_add_u32 v162, v8, 2, v1
    v_lshlrev_b32 v162, 1, v162
    s_lshl_b32 s39, s32, 5
    s_mov_b32 s44, s22
    s_mov_b32 s45, s23
    s_mov_b32 s46, 896
    s_mov_b32 s47, 0x20000
    buffer_load_ushort v160, v162, s[44:47], s39 offen
    s_mov_b32 s40, s4
    s_mov_b32 s41, s5
    s_mov_b32 s42, 7168
    s_mov_b32 s43, 0x20000
    s_mul_i32 s37, s31, 896
    s_add_u32 s63, s37, s39
    buffer_load_ushort v161, v162, s[40:43], s63 offen
    s_mov_b32 s44, s24
    s_mov_b32 s45, s25
    s_mov_b32 s46, 7168
    s_mov_b32 s47, 0x20000
    s_waitcnt vmcnt(4)
    v_perm_b32 v90, v140, v136, s80
    v_perm_b32 v106, v142, v138, s80
    v_perm_b32 v94, v140, v136, s81
    v_perm_b32 v110, v142, v138, s81
    v_perm_b32 v98, v141, v137, s80
    v_perm_b32 v114, v143, v139, s80
    v_perm_b32 v102, v141, v137, s81
    v_perm_b32 v118, v143, v139, s81
    s_waitcnt vmcnt(2)
    v_perm_b32 v91, v148, v144, s80
    v_perm_b32 v107, v150, v146, s80
    v_perm_b32 v95, v148, v144, s81
    v_perm_b32 v111, v150, v146, s81
    v_perm_b32 v99, v149, v145, s80
    v_perm_b32 v115, v151, v147, s80
    v_perm_b32 v103, v149, v145, s81
    v_perm_b32 v119, v151, v147, s81
    v_mfma_f32_16x16x32_bf16 v[48:51], v[32:35], v[88:91], v[48:51]
    v_mfma_f32_16x16x32_bf16 v[52:55], v[32:35], v[104:107], v[52:55]
    s_mov_b32 m0, s67
    s_nop 0
    buffer_load_dwordx4 v163, s[56:59], s64 offen nt lds
    v_mfma_f32_16x16x32_bf16 v[48:51], v[36:39], v[92:95], v[48:51]
    v_mfma_f32_16x16x32_bf16 v[52:55], v[36:39], v[108:111], v[52:55]
    s_add_u32 m0, s67, 1024
    s_nop 0
    buffer_load_dwordx4 v163, s[56:59], s65 offen nt lds
    v_mfma_f32_16x16x32_bf16 v[48:51], v[40:43], v[96:99], v[48:51]
    v_mfma_f32_16x16x32_bf16 v[52:55], v[40:43], v[112:115], v[52:55]
    s_mov_b32 m0, s68
    s_nop 0
    buffer_load_dwordx4 v163, s[48:51], s66 offen nt lds
    v_mfma_f32_16x16x32_bf16 v[48:51], v[44:47], v[100:103], v[48:51]
    v_mfma_f32_16x16x32_bf16 v[52:55], v[44:47], v[116:119], v[52:55]
L_tail:
    s_nop 6
    ds_write_b128 v3, v[48:51]
    ds_write_b128 v3, v[52:55] offset:16
    v_mov_b32 v9, s85
    s_cmp_eq_u32 s87, 0
    s_waitcnt lgkmcnt(0)
    s_barrier
    ds_read2st64_b32 v[16:17], v4 offset0:0 offset1:8
    ds_read2st64_b32 v[18:19], v4 offset0:16 offset1:24
    ds_read2st64_b32 v[20:21], v4 offset0:32 offset1:40
    ds_read2st64_b32 v[22:23], v4 offset0:48 offset1:56
    ds_read_b128 v[24:27], v5
    ds_read_b128 v[28:31], v5 offset:16
    s_waitcnt lgkmcnt(0)
    v_mul_f32 v32, v16, v24
    v_mul_f32 v33, v17, v25
    v_fmac_f32 v32, v18, v26
    v_fmac_f32 v33, v19, v27
    v_fmac_f32 v32, v20, v28
    v_fmac_f32 v33, v21, v29
    v_fmac_f32 v32, v22, v30
    v_fmac_f32 v33, v23, v31
    v_add_f32 v32, v32, v33
    v_bfi_b32 v32, s82, v9, v32
    s_cbranch_scc1 L_owt
    buffer_store_dword v32, v6, s[52:55], s60 offen
L_owe:
    s_cmp_lt_u32 s32, 28
    s_cbranch_scc0 L_end
    buffer_load_dwordx4 v[16:19], v2, s[52:55], s61 offen sc1
    buffer_load_dwordx4 v[20:23], v2, s[52:55], s61 offen offset:256 sc1
    v_and_b32 v10, 7, v0
    v_mul_u32_u24 v10, 136, v10
    v_lshl_add_u32 v10, v1, 3, v10
    v_add_u32 v10, 79936, v10
    ds_read_b64 v[92:93], v10 offset:0
    ds_read_b64 v[94:95], v10 offset:32
    ds_read_b64 v[96:97], v10 offset:64
    ds_read_b64 v[98:99], v10 offset:96
    v_and_b32 v4, 15, v0
    v_lshlrev_b32 v4, 3, v4
    v_and_b32 v5, 1, v1
    v_lshl_add_u32 v4, v5, 2, v4
    v_lshrrev_b32 v5, 1, v1
    v_lshl_add_u32 v4, v5, 7, v4
    s_mul_i32 s37, s30, 264
    s_add_u32 s37, s37, 77824
    v_add_u32 v5, s37, v4
    v_and_b32 v12, 7, v0
    v_mul_u32_u24 v12, 264, v12
    v_lshl_add_u32 v12, v1, 3, v12
    v_add_u32 v12, 77824, v12
    s_and_b32 s60, s32, 28
    s_add_u32 s60, s60, s30
    s_lshl_b32 s60, s60, 5
    s_lshl_b32 s37, s31, 2
    s_add_u32 s60, s60, s37
    s_and_b32 s37, s32, 3
    s_add_u32 s60, s60, s37
    s_lshl_b32 s60, s60, 9
    s_add_u32 s60, s60, 131072
    s_mov_b32 s86, 65536
    s_branch L_gchk
L_gpoll:
    s_mov_b64 exec, vcc
    buffer_load_dwordx4 v[16:19], v2, s[52:55], s61 offen sc1
    buffer_load_dwordx4 v[20:23], v2, s[52:55], s61 offen offset:256 sc1
L_gchk:
    s_waitcnt vmcnt(0)
    v_xor_b32 v16, s85, v16
    v_xor_b32 v17, s85, v17
    v_xor_b32 v18, s85, v18
    v_xor_b32 v19, s85, v19
    v_xor_b32 v20, s85, v20
    v_xor_b32 v21, s85, v21
    v_xor_b32 v22, s85, v22
    v_xor_b32 v23, s85, v23
    v_or_b32 v4, v16, v17
    v_or3_b32 v10, v18, v19, v20
    v_or3_b32 v4, v4, v21, v22
    v_or3_b32 v4, v4, v10, v23
    v_and_b32 v4, 1023, v4
    v_cmp_ne_u32 vcc, 0, v4
    s_sub_u32 s86, s86, 1
    s_cbranch_scc1 L_gdone
    s_cbranch_vccnz L_gpoll
L_gdone:
    s_mov_b64 exec, -1
    v_permlane16_swap_b32 v16, v18
    v_permlane16_swap_b32 v17, v19
    v_permlane16_swap_b32 v20, v22
    v_permlane16_swap_b32 v21, v23
    v_add_f32 v16, v16, v18
    v_add_f32 v17, v17, v19
    v_add_f32 v20, v20, v22
    v_add_f32 v21, v21, v23
    s_nop 0
    v_permlane32_swap_b32 v16, v20
    v_permlane32_swap_b32 v17, v21
    v_add_f32 v16, v16, v20
    v_add_f32 v17, v17, v21
    v_cvt_pk_bf16_f32 v16, v16, v17
    ds_write_b32 v5, v16
    s_waitcnt lgkmcnt(0)
    s_barrier
    s_cmp_lt_u32 s30, 4
    s_cbranch_scc0 L_fin
    ds_read_b64_tr_b16 v[100:101], v7 offset:16384
    ds_read_b64_tr_b16 v[102:103], v7 offset:18432
    ds_read_b64_tr_b16 v[104:105], v7 offset:20480
    ds_read_b64_tr_b16 v[106:107], v7 offset:22528
    ds_read_b64 v[72:73], v12 offset:0
    ds_read_b64 v[74:75], v12 offset:32
    ds_read_b64_tr_b16 v[56:57], v7 offset:0
    ds_read_b64_tr_b16 v[58:59], v7 offset:2048
    ds_read_b64 v[76:77], v12 offset:64
    ds_read_b64 v[78:79], v12 offset:96
    ds_read_b64_tr_b16 v[60:61], v7 offset:4096
    ds_read_b64_tr_b16 v[62:63], v7 offset:6144
    s_waitcnt lgkmcnt(10)
    v_mfma_f32_16x16x32_bf16 v[88:91], v[92:95], v[100:103], 0
    s_waitcnt lgkmcnt(8)
    v_mfma_f32_16x16x32_bf16 v[88:91], v[96:99], v[104:107], v[88:91]
    ds_read_b64 v[80:81], v12 offset:128
    ds_read_b64 v[82:83], v12 offset:160
    ds_read_b64_tr_b16 v[64:65], v7 offset:8192
    ds_read_b64_tr_b16 v[66:67], v7 offset:10240
    ds_read_b64 v[84:85], v12 offset:192
    ds_read_b64 v[86:87], v12 offset:224
    ds_read_b64_tr_b16 v[68:69], v7 offset:12288
    ds_read_b64_tr_b16 v[70:71], v7 offset:14336
    s_waitcnt lgkmcnt(12)
    v_mfma_f32_16x16x32_bf16 v[88:91], v[72:75], v[56:59], v[88:91]
    s_waitcnt lgkmcnt(8)
    v_mfma_f32_16x16x32_bf16 v[88:91], v[76:79], v[60:63], v[88:91]
    s_waitcnt lgkmcnt(4)
    v_mfma_f32_16x16x32_bf16 v[88:91], v[80:83], v[64:67], v[88:91]
    s_waitcnt lgkmcnt(0)
    v_mfma_f32_16x16x32_bf16 v[88:91], v[84:87], v[68:71], v[88:91]
    s_nop 7
    v_permlane32_swap_b32 v88, v89
    v_permlane32_swap_b32 v90, v91
    v_add_u32 v88, 512, v88
    v_add_u32 v90, 512, v90
    v_bfi_b32 v88, s82, v9, v88
    v_bfi_b32 v90, s82, v9, v90
    buffer_store_dword v88, v6, s[52:55], s60 offen sc1
    buffer_store_dword v90, v6, s[52:55], s60 offen offset:256 sc1
    s_endpgm
L_owt:
    buffer_store_dword v32, v6, s[52:55], s60 offen sc1
    s_branch L_owe
L_fin:
    s_cmp_eq_u32 s30, 7
    s_cbranch_scc0 L_end
    v_and_b32 v8, 3, v0
    v_lshrrev_b32 v2, 2, v0
    v_lshlrev_b32 v2, 9, v2
    v_lshl_add_u32 v2, v8, 4, v2
    v_add_u32 v3, 8192, v2
    s_lshl_b32 s61, s32, 14
    s_and_b32 s37, s31, 3
    s_lshl_b32 s37, s37, 7
    s_add_u32 s61, s61, s37
    s_lshr_b32 s37, s31, 2
    s_lshl_b32 s37, s37, 6
    s_add_u32 s61, s61, s37
    s_add_u32 s61, s61, 131072
    s_mov_b32 s86, 65536
    v_lshlrev_b32 v24, 16, v160
    v_lshlrev_b32 v25, 16, v161
    v_add_f32 v24, v24, v25
L_fpoll:
    buffer_load_dwordx4 v[16:19], v2, s[52:55], s61 offen sc1
    buffer_load_dwordx4 v[20:23], v3, s[52:55], s61 offen sc1
    s_waitcnt vmcnt(0)
    v_xor_b32 v16, s85, v16
    v_xor_b32 v17, s85, v17
    v_xor_b32 v18, s85, v18
    v_xor_b32 v19, s85, v19
    v_xor_b32 v20, s85, v20
    v_xor_b32 v21, s85, v21
    v_xor_b32 v22, s85, v22
    v_xor_b32 v23, s85, v23
    v_or_b32 v10, v16, v17
    v_or3_b32 v8, v18, v19, v20
    v_or3_b32 v10, v10, v21, v22
    v_or3_b32 v10, v10, v8, v23
    v_and_b32 v10, 1023, v10
    v_cmp_ne_u32 vcc, 0, v10
    s_sub_u32 s86, s86, 1
    s_cbranch_scc1 L_fdone
    s_cbranch_vccz L_fdone
    s_mov_b64 exec, vcc
    s_branch L_fpoll
L_fdone:
    s_mov_b64 exec, -1
    v_add_f32 v16, v16, v20
    v_add_f32 v17, v17, v21
    v_add_f32 v18, v18, v22
    v_add_f32 v19, v19, v23
    v_permlane16_swap_b32 v16, v17
    s_nop 0
    v_permlane16_swap_b32 v18, v19
    v_add_f32 v16, v16, v17
    v_add_f32 v18, v18, v19
    s_nop 1
    v_permlane32_swap_b32 v16, v18
    v_add_f32 v16, v16, v18
    s_nop 1
    v_add_f32_dpp v16, v16, v16 row_ror:4 row_mask:0xf bank_mask:0xf
    s_nop 1
    v_add_f32_dpp v16, v16, v16 row_ror:8 row_mask:0xf bank_mask:0xf
    v_add_f32 v16, v16, v24
    v_cvt_pk_bf16_f32 v16, v16, v16
    s_mov_b32 exec_lo, 0x000f000f
    s_mov_b32 exec_hi, 0x000f000f
    buffer_store_short v16, v162, s[44:47], s63 offen
    s_cmp_lg_u32 s2, 0
    s_cbranch_scc1 L_noep
    v_mov_b32 v8, 0
    v_mov_b32 v9, s84
    s_mov_b64 exec, 1
    buffer_store_dword v9, v8, s[52:55], 0 offen
L_noep:
    s_endpgm
L_end:
    s_endpgm
.section .rodata,"a"
.p2align 6
.amdhsa_kernel parallel_sum__gqa_block_cached__mixer_channel_mlp__decode_kernel
  .amdhsa_next_free_vgpr 164
  .amdhsa_next_free_sgpr 102
  .amdhsa_accum_offset 164
  .amdhsa_group_segment_fixed_size 0
  .amdhsa_kernarg_size 104
  .amdhsa_user_sgpr_count 2
  .amdhsa_user_sgpr_kernarg_segment_ptr 1
  .amdhsa_system_sgpr_workgroup_id_x 1
.end_amdhsa_kernel
```
